```python
import torch

def _softmax(x, axis=-1):
    return torch.softmax(x, dim=axis)
def _gelu(x):
    return torch.nn.functional.gelu(x, approximate="tanh")
def _silu(x):
    return torch.nn.functional.silu(x)
def _sigmoid(x):
    return torch.sigmoid(x)
def _layernorm(x, axis=-1, eps=1e-5):
    m = x.mean(dim=axis, keepdim=True)
    v = x.var(dim=axis, keepdim=True, unbiased=False)
    return (x - m) / torch.sqrt(v + eps)
def _scatter_add(tgt, idx, src, axis=0):
    return tgt.clone().index_add_(axis, idx, src)
def _segment_sum(src, seg, n):
    out = torch.zeros((n,) + src.shape[1:], dtype=src.dtype)
    return out.index_add_(0, seg, src)
def _pad(x, pw):
    flat = tuple(v for pair in reversed(pw) for v in pair)
    return torch.nn.functional.pad(x, flat)

kernel_name = 'gated_mix__sliding_block_cached__mixer_channel_mlp__decode'

def setup_inputs():

    _w = (lambda a: (lambda t: t.to(torch.bfloat16) if t.is_floating_point() else t)(torch.as_tensor(a)))
    def _A_setup():
        B, Sq, D = 8, 1, 576
        Hq, Hkv, Sk, Dh = 32, 16, 8192, 128
        assert Hq % Hkv == 0, (Hq, Hkv)
        return {
            "x": _w((lambda *s: torch.randn(*s, dtype=torch.bfloat16) * 0.05)(B, Sq, D)),
            "k_cache": _w((lambda *s: torch.randn(*s, dtype=torch.bfloat16) * 6.4)(B, Hkv, Sk, Dh)),
            "v_cache": _w((lambda *s: torch.randn(*s, dtype=torch.bfloat16) * 0.4)(B, Hkv, Sk, Dh)),
            "wq": _w((lambda *s: torch.randn(*s, dtype=torch.bfloat16) * 6.4)(D, Hq * Dh) * (D ** -0.5)),
            "wo": _w((lambda *s: torch.randn(*s, dtype=torch.bfloat16) * 0.4)(Hq * Dh, D) * ((Hq * Dh) ** -0.5)),
        }
    _A_in = _A_setup()

    def _B_setup():
        B, S, D, F = 8, 1, 576, 4608
        return {
            "x": _w((lambda *s: torch.randn(*s, dtype=torch.bfloat16) * 0.05)(B, S, D)),
            "w1": _w((lambda *s: torch.randn(*s, dtype=torch.bfloat16) * 0.8)(D, F) * (D ** -0.5)),
            "b1": _w((lambda *s: torch.randn(*s, dtype=torch.bfloat16) * 0.8)(F)),
            "w2": _w((lambda *s: torch.randn(*s, dtype=torch.bfloat16) * 0.05)(F, D) * (F ** -0.5)),
            "b2": _w((lambda *s: torch.randn(*s, dtype=torch.bfloat16) * 0.05)(D)),
        }
    _B_in = _B_setup()

    return {
        "A_x": _A_in["x"],
        "A_k_cache": _A_in["k_cache"],
        "A_v_cache": _A_in["v_cache"],
        "A_wq": _A_in["wq"],
        "A_wo": _A_in["wo"],
        "B_x": _B_in["x"],
        "B_w1": _B_in["w1"],
        "B_b1": _B_in["b1"],
        "B_w2": _B_in["w2"],
        "B_b2": _B_in["b2"],
        "gate_w": _w((lambda *s: torch.randn(*s, dtype=torch.bfloat16) * 0.05)(576) * 16.0),
    }

def reference(A_x, A_k_cache, A_v_cache, A_wq, A_wo, B_x, B_w1, B_b1, B_w2, B_b2, gate_w):
    def _A_ref(x, k_cache, v_cache, wq, wo):
        B, Sq, D = x.shape
        Hq, Dh = 32, 128
        Hkv, Sk = k_cache.shape[1], k_cache.shape[2]
        W = min(4096, max(256, Sk // 4))
        rep = Hq // Hkv
        q = (lambda x, *d: x.permute(*d))((x @ wq).reshape(B, Sq, Hq, Dh), 0, 2, 1, 3)
        k = (lambda x, n, axis: torch.repeat_interleave(x, n, dim=axis))(k_cache[:, :, Sk - W:, :], rep, axis=1)
        v = (lambda x, n, axis: torch.repeat_interleave(x, n, dim=axis))(v_cache[:, :, Sk - W:, :], rep, axis=1)
        scores = torch.einsum("bhqd,bhkd->bhqk", q, k) * (Dh ** -0.5)
        p = _softmax(scores, axis=-1)
        o = torch.einsum("bhqk,bhkd->bhqd", p, v)
        return (lambda x, *d: x.permute(*d))(o, 0, 2, 1, 3).reshape(B, Sq, Hq * Dh) @ wo

    def _B_ref(x, w1, b1, w2, b2):
        y = _layernorm(x, axis=-1)
        h = _gelu(torch.einsum("bsd,df->bsf", y, w1) + b1)
        return torch.einsum("bsf,fd->bsd", h, w2) + b2

    x = A_x
    g = _sigmoid((x * gate_w).sum(-1, keepdims=True))
    a = _A_ref(x, A_k_cache, A_v_cache, A_wq, A_wo)
    b = _B_ref(x, B_w1, B_b1, B_w2, B_b2)
    return g * a + (1 - g) * b
```

```asm
; @launch grid=(256,1,1) block=(512,1,1) lds=147456
.amdgcn_target "amdgcn-amd-amdhsa--gfx950"
.text
.globl gated_mix__sliding_block_cached__mixer_channel_mlp__decode_kernel
.p2align 8
.type gated_mix__sliding_block_cached__mixer_channel_mlp__decode_kernel,@function
gated_mix__sliding_block_cached__mixer_channel_mlp__decode_kernel:
  s_cmp_ge_u32 s2, 256
  s_cbranch_scc1 L_end
  s_load_dwordx16 s[8:23], s[0:1], 0
  s_load_dwordx8 s[24:31], s[0:1], 64
  s_load_dwordx4 s[32:35], s[0:1], 96
  v_lshrrev_b32 v5, 6, v0
  v_and_b32 v0, 63, v0
  v_readfirstlane_b32 s3, v5
  v_lshlrev_b32 v2, 4, v0
  s_cmp_lg_u32 s3, 6
  s_cbranch_scc1 L_nopf
  s_getpc_b64 s[70:71]
L_pc:
  v_lshlrev_b32 v5, 7, v0
  v_add_u32 v6, 0x2000, v5
  v_min_u32 v5, L_end-L_pc, v5
  v_min_u32 v6, L_end-L_pc, v6
  global_load_dword v28, v5, s[70:71]
  global_load_dword v29, v6, s[70:71]
L_nopf:
  v_lshrrev_b32 v5, 4, v0
  v_lshlrev_b32 v3, 3, v5
  v_bfe_u32 v6, v0, 3, 1
  v_lshl_or_b32 v3, v6, 5, v3
  v_and_b32 v4, 7, v0
  v_lshlrev_b32 v6, 4, v4
  v_lshl_add_u32 v15, v3, 13, v6
  v_mul_u32_u24 v5, 1152, v4
  v_lshl_add_u32 v5, v3, 1, v5
  s_lshl_b32 s83, s3, 10
  s_add_u32 s83, s83, 49152
  s_and_b32 s77, s2, 7
  s_lshr_b32 s70, s2, 3
  s_mul_i32 s78, s70, 57
  s_lshr_b32 s78, s78, 9
  s_mul_i32 s71, s78, 9
  s_sub_u32 s76, s70, s71
  s_mul_i32 s70, s76, 86
  s_lshr_b32 s70, s70, 8
  s_mul_i32 s71, s70, 3
  s_sub_u32 s82, s76, s71
  s_lshl_b32 s70, s70, 2
  s_lshr_b32 s81, 0x763, s70
  s_movk_i32 s75, 1152
  s_mov_b32 s80, 8
  s_lshl_b32 s72, s77, 9
  s_cmp_eq_u32 s78, 0
  s_cbranch_scc1 L_rdone
  s_mov_b32 s80, 9
  s_mul_i32 s72, s77, 576
  s_cmp_eq_u32 s78, 1
  s_cbranch_scc1 L_rdone
  s_lshl_b32 s70, s76, 2
  s_lshr_b32 s81, 0x54210, s70
  s_mov_b32 s82, 0
  s_movk_i32 s75, 8192
  s_movk_i32 s72, 192
  s_mov_b32 s80, 0
  s_cmp_eq_u32 s78, 3
  s_cbranch_scc1 L_rdone
  s_movk_i32 s75, 9216
  s_mov_b32 s72, 0
  s_mov_b32 s80, 9
  s_mul_i32 s70, s77, 9
  s_add_u32 s76, s76, s70
L_rdone:
  s_and_b32 s81, s81, 7
  s_lshl_b32 s70, s77, 3
  s_or_b32 s81, s81, s70
  s_mul_i32 s73, s82, 192
  s_add_u32 s73, s73, s3
  s_lshl_b32 s73, s73, 13
  v_mad_u32_u24 v9, v3, s75, v6
  s_add_u32 s72, s72, s3
  s_mul_i32 s72, s72, s75
  s_lshl_b32 s74, s75, 6
  s_lshl_b32 s70, s81, 7
  s_mul_i32 s71, s82, 384
  s_lshl_b32 s101, s3, 7
  s_add_u32 s71, s71, s101
  s_waitcnt lgkmcnt(0)
  s_add_u32 s52, s14, s70
  s_addc_u32 s53, s15, 0
  s_sub_u32 s54, 4718592, s70
  s_mov_b32 s55, 0x20000
  s_sub_u32 s70, s78, 1
  s_cmp_lt_u32 s70, 2
  s_cbranch_scc1 L_noq
  s_add_u32 m0, s83, 0
  s_nop 0
  buffer_load_dwordx4 v15, s[52:55], s73 offen nt lds
  s_add_u32 s73, s73, 524288
  s_add_u32 m0, s83, 8192
  s_nop 0
  buffer_load_dwordx4 v15, s[52:55], s73 offen nt lds
  s_add_u32 s73, s73, 524288
  s_add_u32 m0, s83, 16384
  s_nop 0
  buffer_load_dwordx4 v15, s[52:55], s73 offen nt lds
L_noq:
  s_load_dword s18, s[34:35], 0
  s_mov_b32 s48, s8
  s_mov_b32 s49, s9
  s_mov_b32 s50, 9216
  s_mov_b32 s51, 0x20000
  s_lshl_b32 s70, s76, 7
  s_cmp_eq_u32 s78, 1
  s_cbranch_scc1 L_m2srd
  s_cmp_lg_u32 s78, 0
  s_cbranch_scc1 L_xall
  s_add_u32 s52, s16, s70
  s_addc_u32 s53, s17, 0
  s_sub_u32 s54, 4718592, s70
  s_mov_b32 s55, 0x20000
  s_cmp_ge_u32 s3, 3
  s_cbranch_scc1 L_wload
  buffer_load_dwordx4 v[96:99], v5, s[48:51], s71 offen
  s_branch L_wload
L_m2srd:
  s_add_u32 s52, s24, s70
  s_addc_u32 s53, s25, 0
  s_sub_u32 s54, 5308416, s70
  s_mov_b32 s55, 0x20000
  s_branch L_wload
L_xall:
  buffer_load_dwordx4 v[96:99], v5, s[48:51], s71 offen
  s_cmp_lg_u32 s3, 7
  s_cbranch_scc1 L_s1x
  buffer_load_dwordx4 v[100:103], v5, s[48:51], 0 offen offset:1024
L_s1x:
  s_cmp_eq_u32 s78, 3
  s_cbranch_scc1 L_wload
  s_add_u32 s52, s20, s70
  s_addc_u32 s53, s21, 0
  s_sub_u32 s54, 5308416, s70
  s_mov_b32 s55, 0x20000
L_wload:
  s_add_u32 m0, s83, 24576
  s_nop 0
  buffer_load_dwordx4 v9, s[52:55], s72 offen nt lds
  s_add_u32 s72, s72, s74
  s_add_u32 m0, s83, 32768
  s_nop 0
  buffer_load_dwordx4 v9, s[52:55], s72 offen nt lds
  s_add_u32 s72, s72, s74
  s_cmp_lg_u32 s78, 3
  s_cbranch_scc1 L_wq
  s_add_u32 m0, s83, 40960
  s_nop 0
  buffer_load_dwordx4 v9, s[52:55], s72 offen nt lds
  s_add_u32 s72, s72, s74
  s_add_u32 m0, s83, 49152
  s_nop 0
  buffer_load_dwordx4 v9, s[52:55], s72 offen nt lds
  s_add_u32 s72, s72, s74
  s_add_u32 m0, s83, 57344
  s_nop 0
  buffer_load_dwordx4 v9, s[52:55], s72 offen nt lds
  s_add_u32 s72, s72, s74
  s_add_u32 m0, s83, 65536
  s_nop 0
  buffer_load_dwordx4 v9, s[52:55], s72 offen nt lds
  s_add_u32 s72, s72, s74
L_wq:
  s_mov_b32 s44, s34
  s_mov_b32 s45, s35
  s_mov_b32 s46, 16777216
  s_mov_b32 s47, 0x20000
  v_and_b32 v1, 48, v0
  v_bfe_u32 v5, v0, 1, 1
  v_lshl_or_b32 v1, v5, 10, v1
  v_bfe_u32 v5, v0, 2, 2
  v_lshl_or_b32 v1, v5, 8, v1
  v_and_b32 v5, 1, v0
  v_lshl_or_b32 v1, v5, 6, v1
  s_mov_b32 s60, 0
  s_mov_b32 s61, 32768
  s_mov_b32 s62, 65536
  s_mov_b32 s63, 98304
  s_mov_b32 s64, 131072
  s_mov_b32 s65, 163840
  s_mov_b32 s66, 196608
  s_mov_b32 s67, 229376
  s_and_b32 s19, s2, 0xe0
  s_lshl_b32 s70, s77, 2
  s_or_b32 s19, s19, s70
  s_bfe_u32 s70, s2, 0x10003
  s_lshl_b32 s70, s70, 1
  s_or_b32 s19, s19, s70
  s_bfe_u32 s70, s2, 0x10004
  s_or_b32 s19, s19, s70
  s_lshr_b32 s70, s19, 1
  s_lshl_b32 s70, s70, 21
  s_and_b32 s71, s19, 1
  s_lshl_b32 s71, s71, 18
  s_add_u32 s70, s70, s71
  s_lshl_b32 s71, s3, 12
  s_add_u32 s70, s70, s71
  s_add_u32 s70, s70, 0x180000
  s_add_u32 s36, s10, s70
  s_addc_u32 s37, s11, 0
  s_sub_u32 s38, 0x10000000, s70
  s_mov_b32 s39, 0x20000
  s_add_u32 s40, s12, s70
  s_addc_u32 s41, s13, 0
  s_sub_u32 s42, 0x10000000, s70
  s_mov_b32 s43, 0x20000
  s_waitcnt vmcnt(4)
  buffer_load_dwordx4 v[128:131], v1, s[36:39], s60 offen offset:0 nt
  s_mov_b32 s68, 0x05040100
  s_mov_b32 s69, 0x07060302
  v_lshrrev_b32 v5, 4, v0
  v_mul_u32_u24 v5, 1152, v5
  v_mul_u32_u24 v6, 144, v4
  s_mul_i32 s70, s3, 4608
  v_add3_u32 v14, v5, v6, s70
  v_lshrrev_b32 v5, 5, v0
  v_mul_u32_u24 v5, 1152, v5
  v_lshl_add_u32 v5, v4, 4, v5
  v_bfe_u32 v6, v0, 3, 2
  v_lshl_add_u32 v5, v6, 2, v5
  s_mul_i32 s70, s3, 144
  v_add_u32 v13, s70, v5
  s_lshl_b32 s71, s3, 8
  s_add_u32 s71, s71, s2
  s_sub_u32 s101, s71, 72
  s_movk_i32 s6, 4095
  s_mov_b32 s7, 0
  s_lshl_b32 s70, s3, 13
  v_add_u32 v15, s70, v2
  s_waitcnt vmcnt(4)
  buffer_load_dwordx4 v[132:135], v1, s[36:39], s60 offen offset:128 nt
  s_waitcnt lgkmcnt(0)
  s_add_u32 s4, s18, 1
  s_and_b32 s5, s4, s6
  v_mov_b32 v12, s4
  s_cmp_lg_u32 s3, 5
  s_cbranch_scc1 L_1
  s_getreg_b32 s70, hwreg(HW_REG_XCC_ID, 0, 4)
  v_lshl_or_b32 v5, v12, 8, s70
  s_lshl_b32 s70, s77, 7
  s_lshr_b32 s71, s2, 3
  s_lshl_b32 s71, s71, 2
  s_add_u32 s70, s70, s71
  s_add_u32 s70, s70, 4096
  s_mov_b64 exec, 1
  buffer_store_dword v5, off, s[44:47], s70
  s_mov_b64 exec, -1
L_1:
  s_cmp_lg_u32 s78, 0
  s_cbranch_scc1 L_role_2
  s_waitcnt vmcnt(4)
  s_barrier
  s_cmp_ge_u32 s3, 3
  s_cbranch_scc1 L_role_2
  ds_read_b128 v[64:67], v15 offset:49152
  ds_read_b128 v[68:71], v15 offset:50176
  ds_read_b128 v[72:75], v15 offset:51200
  ds_read_b128 v[76:79], v15 offset:52224
  ds_read_b128 v[80:83], v15 offset:53248
  ds_read_b128 v[84:87], v15 offset:54272
  ds_read_b128 v[88:91], v15 offset:55296
  ds_read_b128 v[92:95], v15 offset:56320
  s_waitcnt lgkmcnt(0)
  v_perm_b32 v24, v68, v64, s68
  v_perm_b32 v25, v76, v72, s68
  v_perm_b32 v26, v84, v80, s68
  v_perm_b32 v27, v92, v88, s68
  s_nop 1
  v_mfma_f32_16x16x32_bf16 v[32:35], v[24:27], v[96:99], 0
  v_perm_b32 v28, v68, v64, s69
  v_perm_b32 v29, v76, v72, s69
  v_perm_b32 v30, v84, v80, s69
  v_perm_b32 v31, v92, v88, s69
  s_nop 1
  v_mfma_f32_16x16x32_bf16 v[36:39], v[28:31], v[96:99], 0
  v_perm_b32 v24, v69, v65, s68
  v_perm_b32 v25, v77, v73, s68
  v_perm_b32 v26, v85, v81, s68
  v_perm_b32 v27, v93, v89, s68
  s_nop 1
  v_mfma_f32_16x16x32_bf16 v[40:43], v[24:27], v[96:99], 0
  v_perm_b32 v28, v69, v65, s69
  v_perm_b32 v29, v77, v73, s69
  v_perm_b32 v30, v85, v81, s69
  v_perm_b32 v31, v93, v89, s69
  s_nop 1
  v_mfma_f32_16x16x32_bf16 v[44:47], v[28:31], v[96:99], 0
  v_perm_b32 v24, v70, v66, s68
  v_perm_b32 v25, v78, v74, s68
  v_perm_b32 v26, v86, v82, s68
  v_perm_b32 v27, v94, v90, s68
  s_nop 1
  v_mfma_f32_16x16x32_bf16 v[48:51], v[24:27], v[96:99], 0
  v_perm_b32 v28, v70, v66, s69
  v_perm_b32 v29, v78, v74, s69
  v_perm_b32 v30, v86, v82, s69
  v_perm_b32 v31, v94, v90, s69
  s_nop 1
  v_mfma_f32_16x16x32_bf16 v[52:55], v[28:31], v[96:99], 0
  v_perm_b32 v24, v71, v67, s68
  v_perm_b32 v25, v79, v75, s68
  v_perm_b32 v26, v87, v83, s68
  v_perm_b32 v27, v95, v91, s68
  s_nop 1
  v_mfma_f32_16x16x32_bf16 v[56:59], v[24:27], v[96:99], 0
  v_perm_b32 v28, v71, v67, s69
  v_perm_b32 v29, v79, v75, s69
  v_perm_b32 v30, v87, v83, s69
  v_perm_b32 v31, v95, v91, s69
  s_nop 1
  v_mfma_f32_16x16x32_bf16 v[60:63], v[28:31], v[96:99], 0
  s_mov_b32 exec_lo, 0x00ff00ff
  s_mov_b32 exec_hi, 0xff00ff00
  ds_write_b128 v14, v[32:35] offset:12288
  ds_write_b128 v14, v[36:39] offset:12304
  ds_write_b128 v14, v[40:43] offset:12320
  ds_write_b128 v14, v[44:47] offset:12336
  ds_write_b128 v14, v[48:51] offset:12352
  ds_write_b128 v14, v[52:55] offset:12368
  ds_write_b128 v14, v[56:59] offset:12384
  ds_write_b128 v14, v[60:63] offset:12400
  s_mov_b64 exec, -1
L_role_2:
  s_waitcnt vmcnt(5)
  buffer_load_dwordx4 v[136:139], v1, s[36:39], s60 offen offset:2048 nt
  s_waitcnt vmcnt(6)
  buffer_load_dwordx4 v[140:143], v1, s[36:39], s60 offen offset:2176 nt
  s_cmp_lg_u32 s78, 0
  s_cbranch_scc1 L_role_3
  s_lshl_b32 s70, s82, 17
  s_lshl_b32 s71, s3, 14
  s_add_u32 s70, s70, s71
  s_lshl_b32 s71, s81, 8
  s_add_u32 s70, s70, s71
  s_add_u32 s70, s70, 524288
  v_lshlrev_b32 v6, 2, v0
  s_waitcnt lgkmcnt(0)
  s_barrier
  ds_read_b32 v32, v13 offset:12288
  ds_read_b32 v33, v13 offset:14592
  ds_read_b32 v34, v13 offset:16896
  ds_read_b32 v35, v13 offset:19200
  ds_read_b32 v36, v13 offset:21504
  ds_read_b32 v37, v13 offset:23808
  s_waitcnt lgkmcnt(0)
  v_add_f32 v32, v32, v37
  v_add_f32 v33, v33, v36
  v_add_f32 v34, v34, v35
  v_add_f32 v32, v32, v34
  v_add_f32 v32, v32, v33
  v_add_u32 v32, 2048, v32
  v_bfi_b32 v32, s6, v12, v32
  buffer_store_dword v32, v6, s[44:47], s70 offen
  s_xor_b32 s70, s70, 2097152
  buffer_store_dword v32, v6, s[44:47], s70 offen sc1
L_pub_4:
L_role_3:
  s_cmp_lg_u32 s78, 3
  s_cbranch_scc1 L_role_5
  s_waitcnt vmcnt(4)
  s_barrier
  ds_read_b128 v[64:67], v15 offset:49152
  ds_read_b128 v[68:71], v15 offset:50176
  ds_read_b128 v[72:75], v15 offset:51200
  ds_read_b128 v[76:79], v15 offset:52224
  ds_read_b128 v[80:83], v15 offset:53248
  ds_read_b128 v[84:87], v15 offset:54272
  ds_read_b128 v[88:91], v15 offset:55296
  ds_read_b128 v[92:95], v15 offset:56320
  s_waitcnt lgkmcnt(0)
  v_perm_b32 v120, v68, v64, s68
  v_perm_b32 v121, v76, v72, s68
  v_perm_b32 v122, v84, v80, s68
  v_perm_b32 v123, v92, v88, s68
  s_nop 1
  v_mfma_f32_16x16x32_bf16 v[32:35], v[120:123], v[96:99], 0
  v_perm_b32 v124, v68, v64, s69
  v_perm_b32 v125, v76, v72, s69
  v_perm_b32 v126, v84, v80, s69
  v_perm_b32 v127, v92, v88, s69
  s_nop 1
  v_mfma_f32_16x16x32_bf16 v[36:39], v[124:127], v[96:99], 0
  v_perm_b32 v120, v69, v65, s68
  v_perm_b32 v121, v77, v73, s68
  v_perm_b32 v122, v85, v81, s68
  v_perm_b32 v123, v93, v89, s68
  s_nop 1
  v_mfma_f32_16x16x32_bf16 v[40:43], v[120:123], v[96:99], 0
  v_perm_b32 v124, v69, v65, s69
  v_perm_b32 v125, v77, v73, s69
  v_perm_b32 v126, v85, v81, s69
  v_perm_b32 v127, v93, v89, s69
  s_nop 1
  v_mfma_f32_16x16x32_bf16 v[44:47], v[124:127], v[96:99], 0
  v_perm_b32 v120, v70, v66, s68
  v_perm_b32 v121, v78, v74, s68
  v_perm_b32 v122, v86, v82, s68
  v_perm_b32 v123, v94, v90, s68
  s_nop 1
  v_mfma_f32_16x16x32_bf16 v[48:51], v[120:123], v[96:99], 0
  v_perm_b32 v124, v70, v66, s69
  v_perm_b32 v125, v78, v74, s69
  v_perm_b32 v126, v86, v82, s69
  v_perm_b32 v127, v94, v90, s69
  s_nop 1
  v_mfma_f32_16x16x32_bf16 v[52:55], v[124:127], v[96:99], 0
  v_perm_b32 v120, v71, v67, s68
  v_perm_b32 v121, v79, v75, s68
  v_perm_b32 v122, v87, v83, s68
  v_perm_b32 v123, v95, v91, s68
  s_nop 1
  v_mfma_f32_16x16x32_bf16 v[56:59], v[120:123], v[96:99], 0
  v_perm_b32 v124, v71, v67, s69
  v_perm_b32 v125, v79, v75, s69
  v_perm_b32 v126, v87, v83, s69
  v_perm_b32 v127, v95, v91, s69
  s_nop 1
  v_mfma_f32_16x16x32_bf16 v[60:63], v[124:127], v[96:99], 0
L_role_5:
  s_waitcnt vmcnt(4)
  s_cmp_le_u32 s80, 2
  s_cbranch_scc1 L_6
  s_add_u32 m0, s83, 40960
  s_nop 0
  buffer_load_dwordx4 v9, s[52:55], s72 offen nt lds
  s_add_u32 s72, s72, s74
  s_waitcnt vmcnt(4)
L_6:
  buffer_load_dwordx4 v[144:147], v1, s[36:39], s61 offen offset:0 nt
  s_cmp_lg_u32 s78, 3
  s_cbranch_scc1 L_role_7
  s_cmp_lg_u32 s3, 7
  s_cbranch_scc1 L_8
  v_add_u32 v5, 57344, v15
  ds_read_b128 v[64:67], v5 offset:0
  ds_read_b128 v[68:71], v5 offset:1024
  ds_read_b128 v[72:75], v5 offset:2048
  ds_read_b128 v[76:79], v5 offset:3072
  ds_read_b128 v[80:83], v5 offset:4096
  ds_read_b128 v[84:87], v5 offset:5120
  ds_read_b128 v[88:91], v5 offset:6144
  ds_read_b128 v[92:95], v5 offset:7168
  s_waitcnt lgkmcnt(0)
  v_perm_b32 v120, v68, v64, s68
  v_perm_b32 v121, v76, v72, s68
  v_perm_b32 v122, v84, v80, s68
  v_perm_b32 v123, v92, v88, s68
  s_nop 1
  v_mfma_f32_16x16x32_bf16 v[32:35], v[120:123], v[100:103], v[32:35]
  v_perm_b32 v124, v68, v64, s69
  v_perm_b32 v125, v76, v72, s69
  v_perm_b32 v126, v84, v80, s69
  v_perm_b32 v127, v92, v88, s69
  s_nop 1
  v_mfma_f32_16x16x32_bf16 v[36:39], v[124:127], v[100:103], v[36:39]
  v_perm_b32 v120, v69, v65, s68
  v_perm_b32 v121, v77, v73, s68
  v_perm_b32 v122, v85, v81, s68
  v_perm_b32 v123, v93, v89, s68
  s_nop 1
  v_mfma_f32_16x16x32_bf16 v[40:43], v[120:123], v[100:103], v[40:43]
  v_perm_b32 v124, v69, v65, s69
  v_perm_b32 v125, v77, v73, s69
  v_perm_b32 v126, v85, v81, s69
  v_perm_b32 v127, v93, v89, s69
  s_nop 1
  v_mfma_f32_16x16x32_bf16 v[44:47], v[124:127], v[100:103], v[44:47]
  v_perm_b32 v120, v70, v66, s68
  v_perm_b32 v121, v78, v74, s68
  v_perm_b32 v122, v86, v82, s68
  v_perm_b32 v123, v94, v90, s68
  s_nop 1
  v_mfma_f32_16x16x32_bf16 v[48:51], v[120:123], v[100:103], v[48:51]
  v_perm_b32 v124, v70, v66, s69
  v_perm_b32 v125, v78, v74, s69
  v_perm_b32 v126, v86, v82, s69
  v_perm_b32 v127, v94, v90, s69
  s_nop 1
  v_mfma_f32_16x16x32_bf16 v[52:55], v[124:127], v[100:103], v[52:55]
  v_perm_b32 v120, v71, v67, s68
  v_perm_b32 v121, v79, v75, s68
  v_perm_b32 v122, v87, v83, s68
  v_perm_b32 v123, v95, v91, s68
  s_nop 1
  v_mfma_f32_16x16x32_bf16 v[56:59], v[120:123], v[100:103], v[56:59]
  v_perm_b32 v124, v71, v67, s69
  v_perm_b32 v125, v79, v75, s69
  v_perm_b32 v126, v87, v83, s69
  v_perm_b32 v127, v95, v91, s69
  s_nop 1
  v_mfma_f32_16x16x32_bf16 v[60:63], v[124:127], v[100:103], v[60:63]
L_8:
  s_mov_b32 exec_lo, 0x00ff00ff
  s_mov_b32 exec_hi, 0xff00ff00
  ds_write_b128 v14, v[32:35] offset:12288
  ds_write_b128 v14, v[36:39] offset:12304
  ds_write_b128 v14, v[40:43] offset:12320
  ds_write_b128 v14, v[44:47] offset:12336
  ds_write_b128 v14, v[48:51] offset:12352
  ds_write_b128 v14, v[52:55] offset:12368
  ds_write_b128 v14, v[56:59] offset:12384
  ds_write_b128 v14, v[60:63] offset:12400
  s_mov_b64 exec, -1
L_role_7:
  s_cmp_lg_u32 s78, 2
  s_cbranch_scc1 L_role_9
  s_mov_b32 s70, 0x3f803f80
  v_mov_b32 v120, 0
  v_mov_b32 v121, 0
  s_cmp_lg_u32 s3, 7
  s_cbranch_scc1 L_ln2
  v_dot2_f32_bf16 v120, v100, s70, v120
  v_dot2_f32_bf16 v121, v100, v100, v121
  v_dot2_f32_bf16 v120, v101, s70, v120
  v_dot2_f32_bf16 v121, v101, v101, v121
  v_dot2_f32_bf16 v120, v102, s70, v120
  v_dot2_f32_bf16 v121, v102, v102, v121
  v_dot2_f32_bf16 v120, v103, s70, v120
  v_dot2_f32_bf16 v121, v103, v103, v121
L_ln2:
  v_dot2_f32_bf16 v120, v96, s70, v120
  v_dot2_f32_bf16 v121, v96, v96, v121
  v_dot2_f32_bf16 v120, v97, s70, v120
  v_dot2_f32_bf16 v121, v97, v97, v121
  v_dot2_f32_bf16 v120, v98, s70, v120
  v_dot2_f32_bf16 v121, v98, v98, v121
  v_dot2_f32_bf16 v120, v99, s70, v120
  v_dot2_f32_bf16 v121, v99, v99, v121
  s_nop 1
  v_add_f32_dpp v120, v120, v120 row_ror:8 row_mask:0xf bank_mask:0xf
  v_mov_b32 v6, v120
  s_nop 1
  v_permlane16_swap_b32 v120, v6
  v_add_f32 v120, v120, v6
  v_mov_b32 v6, v120
  s_nop 1
  v_permlane32_swap_b32 v120, v6
  v_add_f32 v120, v120, v6
  v_add_f32_dpp v121, v121, v121 row_ror:8 row_mask:0xf bank_mask:0xf
  v_mov_b32 v7, v121
  s_nop 1
  v_permlane16_swap_b32 v121, v7
  v_add_f32 v121, v121, v7
  v_mov_b32 v7, v121
  s_nop 1
  v_permlane32_swap_b32 v121, v7
  v_add_f32 v121, v121, v7
  v_lshlrev_b32 v5, 6, v4
  s_lshl_b32 s70, s3, 3
  v_add_u32 v6, s70, v5
  s_mov_b64 exec, 0xff
  ds_write_b64 v6, v[120:121] offset:0
  s_mov_b64 exec, -1
  s_mov_b32 s48, s22
  s_mov_b32 s49, s23
  s_mov_b32 s50, 9216
  s_mov_b32 s51, 0x20000
  v_lshlrev_b32 v6, 1, v0
  s_lshl_b32 s70, s76, 7
  buffer_load_ushort v10, v6, s[48:51], s70 offen
L_role_9:
  s_waitcnt vmcnt(4)
  buffer_load_dwordx4 v[148:151], v1, s[36:39], s61 offen offset:128 nt
  s_cmp_lg_u32 s78, 3
  s_cbranch_scc1 L_role_10
  s_lshl_b32 s70, s82, 17
  s_lshl_b32 s71, s3, 14
  s_add_u32 s70, s70, s71
  s_lshl_b32 s71, s81, 8
  s_add_u32 s70, s70, s71
  s_add_u32 s70, s70, 524288
  v_lshlrev_b32 v6, 2, v0
  s_waitcnt lgkmcnt(0)
  s_barrier
  ds_read_b32 v32, v13 offset:12288
  ds_read_b32 v33, v13 offset:14592
  ds_read_b32 v34, v13 offset:16896
  ds_read_b32 v35, v13 offset:19200
  ds_read_b32 v36, v13 offset:21504
  ds_read_b32 v37, v13 offset:23808
  ds_read_b32 v38, v13 offset:26112
  ds_read_b32 v39, v13 offset:28416
  ds_read_b32 v40, v13 offset:30720
  ds_read_b32 v41, v13 offset:33024
  ds_read_b32 v42, v13 offset:35328
  ds_read_b32 v43, v13 offset:37632
  ds_read_b32 v44, v13 offset:39936
  ds_read_b32 v45, v13 offset:42240
  ds_read_b32 v46, v13 offset:44544
  ds_read_b32 v47, v13 offset:46848
  s_waitcnt lgkmcnt(0)
  v_pk_add_f32 v[32:33], v[32:33], v[40:41]
  v_pk_add_f32 v[34:35], v[34:35], v[42:43]
  v_pk_add_f32 v[36:37], v[36:37], v[44:45]
  v_pk_add_f32 v[38:39], v[38:39], v[46:47]
  v_pk_add_f32 v[32:33], v[32:33], v[36:37]
  v_pk_add_f32 v[34:35], v[34:35], v[38:39]
  v_pk_add_f32 v[32:33], v[32:33], v[34:35]
  v_add_f32 v32, v32, v33
  v_add_u32 v32, 2048, v32
  v_bfi_b32 v32, s6, v12, v32
  buffer_store_dword v32, v6, s[44:47], s70 offen
  s_xor_b32 s70, s70, 2097152
  buffer_store_dword v32, v6, s[44:47], s70 offen sc1
L_pub_11:
L_role_10:
  s_waitcnt vmcnt(3)
  s_cmp_le_u32 s80, 3
  s_cbranch_scc1 L_12
  s_add_u32 m0, s83, 49152
  s_nop 0
  buffer_load_dwordx4 v9, s[52:55], s72 offen nt lds
  s_add_u32 s72, s72, s74
  s_waitcnt vmcnt(3)
L_12:
  buffer_load_dwordx4 v[152:155], v1, s[36:39], s61 offen offset:2048 nt
  s_waitcnt vmcnt(3)
  buffer_load_dwordx4 v[156:159], v1, s[36:39], s61 offen offset:2176 nt
  s_waitcnt vmcnt(3)
  s_cmp_le_u32 s80, 4
  s_cbranch_scc1 L_13
  s_add_u32 m0, s83, 57344
  s_nop 0
  buffer_load_dwordx4 v9, s[52:55], s72 offen nt lds
  s_add_u32 s72, s72, s74
  s_waitcnt vmcnt(3)
L_13:
  buffer_load_dwordx4 v[160:163], v1, s[36:39], s62 offen offset:0 nt
  s_waitcnt vmcnt(3)
  buffer_load_dwordx4 v[164:167], v1, s[36:39], s62 offen offset:128 nt
  s_waitcnt vmcnt(3)
  s_cmp_le_u32 s80, 5
  s_cbranch_scc1 L_14
  s_add_u32 m0, s83, 65536
  s_nop 0
  buffer_load_dwordx4 v9, s[52:55], s72 offen nt lds
  s_add_u32 s72, s72, s74
  s_waitcnt vmcnt(3)
L_14:
  buffer_load_dwordx4 v[168:171], v1, s[36:39], s62 offen offset:2048 nt
  s_waitcnt vmcnt(3)
  buffer_load_dwordx4 v[172:175], v1, s[36:39], s62 offen offset:2176 nt
  s_waitcnt vmcnt(3)
  s_cmp_le_u32 s80, 6
  s_cbranch_scc1 L_15
  s_add_u32 m0, s83, 73728
  s_nop 0
  buffer_load_dwordx4 v9, s[52:55], s72 offen nt lds
  s_add_u32 s72, s72, s74
  s_waitcnt vmcnt(3)
L_15:
  buffer_load_dwordx4 v[176:179], v1, s[36:39], s63 offen offset:0 nt
  s_waitcnt vmcnt(3)
  s_cmp_lg_u32 s3, 2
  s_cbranch_scc1 L_wave_16
  s_lshr_b32 s70, s19, 1
  s_lshl_b32 s70, s70, 10
  s_add_u32 s10, s70, 524288
  s_add_u32 s11, s10, 0x20000
  s_add_u32 s12, s10, 0x40000
  s_bitcmp1_b32 s19, 1
  s_cselect_b32 s13, -1, 0xffff0000
  v_mov_b32 v68, s5
  v_mov_b32 v69, s5
  v_mov_b32 v70, s5
  v_mov_b32 v71, s5
  v_mov_b32 v72, s5
  v_mov_b32 v73, s5
  v_mov_b32 v74, s5
  v_mov_b32 v75, s5
  buffer_load_dwordx4 v[64:67], v2, s[44:47], s10 offen sc1
  s_mov_b32 exec_lo, 0
  s_mov_b32 exec_hi, s13
  buffer_load_dwordx4 v[68:71], v2, s[44:47], s11 offen sc1
  buffer_load_dwordx4 v[72:75], v2, s[44:47], s12 offen sc1
  s_mov_b64 exec, -1
L_wave_16:
  s_cmp_lg_u32 s3, 3
  s_cbranch_scc1 L_wave_17
  v_lshlrev_b32 v5, 2, v0
  s_lshl_b32 s70, s77, 7
  s_add_u32 s70, s70, 4096
  s_mov_b32 exec_hi, 0
  buffer_load_dword v64, v5, s[44:47], s70 offen sc1
  s_mov_b64 exec, -1
L_wave_17:
  buffer_load_dwordx4 v[180:183], v1, s[36:39], s63 offen offset:128 nt
  s_waitcnt vmcnt(3)
  s_cmp_le_u32 s80, 7
  s_cbranch_scc1 L_18
  s_add_u32 m0, s83, 81920
  s_nop 0
  buffer_load_dwordx4 v9, s[52:55], s72 offen nt lds
  s_add_u32 s72, s72, s74
  s_waitcnt vmcnt(3)
L_18:
  buffer_load_dwordx4 v[184:187], v1, s[36:39], s63 offen offset:2048 nt
  s_waitcnt vmcnt(3)
  buffer_load_dwordx4 v[188:191], v1, s[36:39], s63 offen offset:2176 nt
  s_waitcnt vmcnt(3)
  s_cmp_le_u32 s80, 8
  s_cbranch_scc1 L_19
  s_add_u32 m0, s83, 90112
  s_nop 0
  buffer_load_dwordx4 v9, s[52:55], s72 offen nt lds
  s_add_u32 s72, s72, s74
  s_waitcnt vmcnt(3)
L_19:
  buffer_load_dwordx4 v[192:195], v1, s[36:39], s64 offen offset:0 nt
  s_cmp_lg_u32 s3, 2
  s_cbranch_scc1 L_20
  s_mov_b32 s79, 400000
L_poll_21:
  v_xor_b32 v64, s5, v64
  v_xor_b32 v65, s5, v65
  v_xor_b32 v66, s5, v66
  v_xor_b32 v67, s5, v67
  v_xor_b32 v68, s5, v68
  v_xor_b32 v69, s5, v69
  v_xor_b32 v70, s5, v70
  v_xor_b32 v71, s5, v71
  v_xor_b32 v72, s5, v72
  v_xor_b32 v73, s5, v73
  v_xor_b32 v74, s5, v74
  v_xor_b32 v75, s5, v75
  v_or3_b32 v5, v64, v65, v66
  v_or3_b32 v5, v67, v68, v5
  v_or3_b32 v5, v69, v70, v5
  v_or3_b32 v5, v71, v72, v5
  v_or3_b32 v5, v73, v74, v5
  v_or_b32 v5, v75, v5
  v_and_b32 v5, s6, v5
  v_cmp_ne_u32 vcc, 0, v5
  s_nop 0
  s_cbranch_vccz L_ok_22
  s_sub_u32 s79, s79, 1
  s_cbranch_scc1 L_ok_22
  s_sleep 4
  s_xor_b32 s10, s10, 2097152
  s_xor_b32 s11, s11, 2097152
  s_xor_b32 s12, s12, 2097152
  v_mov_b32 v68, s5
  v_mov_b32 v69, s5
  v_mov_b32 v70, s5
  v_mov_b32 v71, s5
  v_mov_b32 v72, s5
  v_mov_b32 v73, s5
  v_mov_b32 v74, s5
  v_mov_b32 v75, s5
  buffer_load_dwordx4 v[64:67], v2, s[44:47], s10 offen sc1
  s_mov_b32 exec_lo, 0
  s_mov_b32 exec_hi, s13
  buffer_load_dwordx4 v[68:71], v2, s[44:47], s11 offen sc1
  buffer_load_dwordx4 v[72:75], v2, s[44:47], s12 offen sc1
  s_mov_b64 exec, -1
  s_waitcnt vmcnt(0)
  s_branch L_poll_21
L_ok_22:
  v_pk_add_f32 v[64:65], v[64:65], v[68:69]
  v_pk_add_f32 v[64:65], v[64:65], v[72:73]
  v_pk_add_f32 v[66:67], v[66:67], v[70:71]
  v_pk_add_f32 v[66:67], v[66:67], v[74:75]
  v_cvt_pk_bf16_f32 v64, v64, v65
  v_cvt_pk_bf16_f32 v65, v66, v67
  v_lshlrev_b32 v5, 3, v0
  ds_write_b64 v5, v[64:65] offset:1024
L_20:
  s_cmp_lg_u32 s3, 3
  s_cbranch_scc1 L_23
  s_getreg_b32 s70, hwreg(HW_REG_XCC_ID, 0, 4)
  s_lshl_b32 s71, s4, 8
  s_or_b32 s70, s70, s71
  v_cmp_eq_u32 vcc, s70, v64
  s_nop 0
  s_cmp_eq_u32 vcc_lo, -1
  s_cselect_b32 s70, 1, 0
  v_mov_b32 v5, s70
  v_mov_b32 v6, 0
  s_mov_b64 exec, 1
  ds_write_b32 v6, v5 offset:2240
  s_mov_b64 exec, -1
L_23:
  v_and_b32 v5, 48, v0
  v_and_b32 v6, 1, v0
  v_lshl_or_b32 v5, v6, 8, v5
  v_bfe_u32 v6, v0, 1, 1
  v_lshl_or_b32 v5, v6, 6, v5
  v_mov_b32 v6, 0
  s_waitcnt lgkmcnt(0)
  s_barrier
  ds_read_b128 v[16:19], v5 offset:1024
  ds_read_b128 v[20:23], v5 offset:1152
  ds_read_b32 v6, v6 offset:2240
  s_waitcnt lgkmcnt(0)
  v_readfirstlane_b32 s7, v6
  s_cmp_lg_u32 s78, 2
  s_cbranch_scc1 L_role_24
  v_lshlrev_b32 v5, 6, v4
  ds_read_b128 v[104:107], v5 offset:0
  ds_read_b128 v[108:111], v5 offset:16
  ds_read_b128 v[112:115], v5 offset:32
  ds_read_b128 v[116:119], v5 offset:48
  s_waitcnt lgkmcnt(0)
  v_pk_add_f32 v[104:105], v[104:105], v[112:113]
  v_pk_add_f32 v[106:107], v[106:107], v[114:115]
  v_pk_add_f32 v[108:109], v[108:109], v[116:117]
  v_pk_add_f32 v[110:111], v[110:111], v[118:119]
  v_pk_add_f32 v[104:105], v[104:105], v[108:109]
  v_pk_add_f32 v[106:107], v[106:107], v[110:111]
  v_pk_add_f32 v[104:105], v[104:105], v[106:107]
  v_mul_f32 v106, 0x3ae38e39, v104
  v_mul_f32 v7, 0x3ae38e39, v105
  v_fma_f32 v7, -v106, v106, v7
  v_max_f32 v7, 0, v7
  v_add_f32 v7, 0x3727c5ac, v7
  v_rsq_f32 v107, v7
  v_lshlrev_b32 v6, 16, v96
  v_and_b32 v8, 0xffff0000, v96
  v_sub_f32 v6, v6, v106
  v_sub_f32 v8, v8, v106
  v_mul_f32 v6, v6, v107
  v_mul_f32 v8, v8, v107
  v_cvt_pk_bf16_f32 v96, v6, v8
  v_lshlrev_b32 v6, 16, v97
  v_and_b32 v8, 0xffff0000, v97
  v_sub_f32 v6, v6, v106
  v_sub_f32 v8, v8, v106
  v_mul_f32 v6, v6, v107
  v_mul_f32 v8, v8, v107
  v_cvt_pk_bf16_f32 v97, v6, v8
  v_lshlrev_b32 v6, 16, v98
  v_and_b32 v8, 0xffff0000, v98
  v_sub_f32 v6, v6, v106
  v_sub_f32 v8, v8, v106
  v_mul_f32 v6, v6, v107
  v_mul_f32 v8, v8, v107
  v_cvt_pk_bf16_f32 v98, v6, v8
  v_lshlrev_b32 v6, 16, v99
  v_and_b32 v8, 0xffff0000, v99
  v_sub_f32 v6, v6, v106
  v_sub_f32 v8, v8, v106
  v_mul_f32 v6, v6, v107
  v_mul_f32 v8, v8, v107
  v_cvt_pk_bf16_f32 v99, v6, v8
  s_cmp_lg_u32 s3, 7
  s_cbranch_scc1 L_role_24
  v_lshlrev_b32 v6, 16, v100
  v_and_b32 v8, 0xffff0000, v100
  v_sub_f32 v6, v6, v106
  v_sub_f32 v8, v8, v106
  v_mul_f32 v6, v6, v107
  v_mul_f32 v8, v8, v107
  v_cvt_pk_bf16_f32 v100, v6, v8
  v_lshlrev_b32 v6, 16, v101
  v_and_b32 v8, 0xffff0000, v101
  v_sub_f32 v6, v6, v106
  v_sub_f32 v8, v8, v106
  v_mul_f32 v6, v6, v107
  v_mul_f32 v8, v8, v107
  v_cvt_pk_bf16_f32 v101, v6, v8
  v_lshlrev_b32 v6, 16, v102
  v_and_b32 v8, 0xffff0000, v102
  v_sub_f32 v6, v6, v106
  v_sub_f32 v8, v8, v106
  v_mul_f32 v6, v6, v107
  v_mul_f32 v8, v8, v107
  v_cvt_pk_bf16_f32 v102, v6, v8
  v_lshlrev_b32 v6, 16, v103
  v_and_b32 v8, 0xffff0000, v103
  v_sub_f32 v6, v6, v106
  v_sub_f32 v8, v8, v106
  v_mul_f32 v6, v6, v107
  v_mul_f32 v8, v8, v107
  v_cvt_pk_bf16_f32 v103, v6, v8
L_role_24:
  s_waitcnt vmcnt(3)
  buffer_load_dwordx4 v[196:199], v1, s[36:39], s64 offen offset:128 nt
  v_mfma_f32_16x16x32_bf16 v[24:27], v[128:131], v[16:19], 0
  v_mfma_f32_16x16x32_bf16 v[24:27], v[132:135], v[20:23], v[24:27]
  v_mfma_f32_16x16x32_bf16 v[128:131], v[136:139], v[16:19], 0
  v_mfma_f32_16x16x32_bf16 v[128:131], v[140:143], v[20:23], v[128:131]
  v_mfma_f32_16x16x32_bf16 v[132:135], v[144:147], v[16:19], 0
  v_mfma_f32_16x16x32_bf16 v[132:135], v[148:151], v[20:23], v[132:135]
  s_waitcnt vmcnt(3)
  buffer_load_dwordx4 v[200:203], v1, s[36:39], s64 offen offset:2048 nt
  v_mfma_f32_16x16x32_bf16 v[136:139], v[152:155], v[16:19], 0
  v_mfma_f32_16x16x32_bf16 v[136:139], v[156:159], v[20:23], v[136:139]
  v_mfma_f32_16x16x32_bf16 v[140:143], v[160:163], v[16:19], 0
  v_mfma_f32_16x16x32_bf16 v[140:143], v[164:167], v[20:23], v[140:143]
  v_mfma_f32_16x16x32_bf16 v[144:147], v[168:171], v[16:19], 0
  v_mfma_f32_16x16x32_bf16 v[144:147], v[172:175], v[20:23], v[144:147]
  v_add_f32_dpp v24, v25, v24 quad_perm:[2,3,0,1] row_mask:0xf bank_mask:0xf
  v_add_f32_dpp v26, v27, v26 quad_perm:[2,3,0,1] row_mask:0xf bank_mask:0xf
  v_add_f32_dpp v128, v129, v128 quad_perm:[2,3,0,1] row_mask:0xf bank_mask:0xf
  v_add_f32_dpp v130, v131, v130 quad_perm:[2,3,0,1] row_mask:0xf bank_mask:0xf
  v_add_f32_dpp v132, v133, v132 quad_perm:[2,3,0,1] row_mask:0xf bank_mask:0xf
  v_add_f32_dpp v134, v135, v134 quad_perm:[2,3,0,1] row_mask:0xf bank_mask:0xf
  v_max_f32 v11, v24, v26
  v_max3_f32 v11, v128, v130, v11
  v_max3_f32 v11, v132, v134, v11
  s_waitcnt vmcnt(3)
  buffer_load_dwordx4 v[204:207], v1, s[36:39], s64 offen offset:2176 nt
  s_cmp_lg_u32 s78, 2
  s_cbranch_scc1 L_role_25
  s_barrier
  v_add_u32 v5, 73728, v15
  ds_read_b128 v[64:67], v5 offset:0
  ds_read_b128 v[68:71], v5 offset:1024
  ds_read_b128 v[72:75], v5 offset:2048
  ds_read_b128 v[76:79], v5 offset:3072
  ds_read_b128 v[80:83], v5 offset:4096
  ds_read_b128 v[84:87], v5 offset:5120
  ds_read_b128 v[88:91], v5 offset:6144
  ds_read_b128 v[92:95], v5 offset:7168
  s_waitcnt lgkmcnt(0)
  v_perm_b32 v120, v68, v64, s68
  v_perm_b32 v121, v76, v72, s68
  v_perm_b32 v122, v84, v80, s68
  v_perm_b32 v123, v92, v88, s68
  s_nop 1
  v_mfma_f32_16x16x32_bf16 v[32:35], v[120:123], v[96:99], 0
  v_perm_b32 v124, v68, v64, s69
  v_perm_b32 v125, v76, v72, s69
  v_perm_b32 v126, v84, v80, s69
  v_perm_b32 v127, v92, v88, s69
  s_nop 1
  v_mfma_f32_16x16x32_bf16 v[36:39], v[124:127], v[96:99], 0
  v_perm_b32 v120, v69, v65, s68
  v_perm_b32 v121, v77, v73, s68
  v_perm_b32 v122, v85, v81, s68
  v_perm_b32 v123, v93, v89, s68
  s_nop 1
  v_mfma_f32_16x16x32_bf16 v[40:43], v[120:123], v[96:99], 0
  v_perm_b32 v124, v69, v65, s69
  v_perm_b32 v125, v77, v73, s69
  v_perm_b32 v126, v85, v81, s69
  v_perm_b32 v127, v93, v89, s69
  s_nop 1
  v_mfma_f32_16x16x32_bf16 v[44:47], v[124:127], v[96:99], 0
  v_perm_b32 v120, v70, v66, s68
  v_perm_b32 v121, v78, v74, s68
  v_perm_b32 v122, v86, v82, s68
  v_perm_b32 v123, v94, v90, s68
  s_nop 1
  v_mfma_f32_16x16x32_bf16 v[48:51], v[120:123], v[96:99], 0
  v_perm_b32 v124, v70, v66, s69
  v_perm_b32 v125, v78, v74, s69
  v_perm_b32 v126, v86, v82, s69
  v_perm_b32 v127, v94, v90, s69
  s_nop 1
  v_mfma_f32_16x16x32_bf16 v[52:55], v[124:127], v[96:99], 0
  v_perm_b32 v120, v71, v67, s68
  v_perm_b32 v121, v79, v75, s68
  v_perm_b32 v122, v87, v83, s68
  v_perm_b32 v123, v95, v91, s68
  s_nop 1
  v_mfma_f32_16x16x32_bf16 v[56:59], v[120:123], v[96:99], 0
  v_perm_b32 v124, v71, v67, s69
  v_perm_b32 v125, v79, v75, s69
  v_perm_b32 v126, v87, v83, s69
  v_perm_b32 v127, v95, v91, s69
  s_nop 1
  v_mfma_f32_16x16x32_bf16 v[60:63], v[124:127], v[96:99], 0
L_role_25:
  v_mfma_f32_16x16x32_bf16 v[148:151], v[176:179], v[16:19], 0
  v_mfma_f32_16x16x32_bf16 v[148:151], v[180:183], v[20:23], v[148:151]
  v_mfma_f32_16x16x32_bf16 v[152:155], v[184:187], v[16:19], 0
  v_mfma_f32_16x16x32_bf16 v[152:155], v[188:191], v[20:23], v[152:155]
  v_add_f32_dpp v136, v137, v136 quad_perm:[2,3,0,1] row_mask:0xf bank_mask:0xf
  v_add_f32_dpp v138, v139, v138 quad_perm:[2,3,0,1] row_mask:0xf bank_mask:0xf
  v_add_f32_dpp v140, v141, v140 quad_perm:[2,3,0,1] row_mask:0xf bank_mask:0xf
  v_add_f32_dpp v142, v143, v142 quad_perm:[2,3,0,1] row_mask:0xf bank_mask:0xf
  v_add_f32_dpp v144, v145, v144 quad_perm:[2,3,0,1] row_mask:0xf bank_mask:0xf
  v_add_f32_dpp v146, v147, v146 quad_perm:[2,3,0,1] row_mask:0xf bank_mask:0xf
  v_max3_f32 v11, v136, v138, v11
  v_max3_f32 v11, v140, v142, v11
  v_max3_f32 v11, v144, v146, v11
  s_waitcnt vmcnt(3)
  buffer_load_dwordx4 v[208:211], v1, s[36:39], s65 offen offset:0 nt
  s_cmp_lg_u32 s78, 2
  s_cbranch_scc1 L_role_26
  s_cmp_lg_u32 s3, 7
  s_cbranch_scc1 L_27
  v_add_u32 v5, 81920, v15
  ds_read_b128 v[64:67], v5 offset:0
  ds_read_b128 v[68:71], v5 offset:1024
  ds_read_b128 v[72:75], v5 offset:2048
  ds_read_b128 v[76:79], v5 offset:3072
  ds_read_b128 v[80:83], v5 offset:4096
  ds_read_b128 v[84:87], v5 offset:5120
  ds_read_b128 v[88:91], v5 offset:6144
  ds_read_b128 v[92:95], v5 offset:7168
  s_waitcnt lgkmcnt(0)
  v_perm_b32 v120, v68, v64, s68
  v_perm_b32 v121, v76, v72, s68
  v_perm_b32 v122, v84, v80, s68
  v_perm_b32 v123, v92, v88, s68
  s_nop 1
  v_mfma_f32_16x16x32_bf16 v[32:35], v[120:123], v[100:103], v[32:35]
  v_perm_b32 v124, v68, v64, s69
  v_perm_b32 v125, v76, v72, s69
  v_perm_b32 v126, v84, v80, s69
  v_perm_b32 v127, v92, v88, s69
  s_nop 1
  v_mfma_f32_16x16x32_bf16 v[36:39], v[124:127], v[100:103], v[36:39]
  v_perm_b32 v120, v69, v65, s68
  v_perm_b32 v121, v77, v73, s68
  v_perm_b32 v122, v85, v81, s68
  v_perm_b32 v123, v93, v89, s68
  s_nop 1
  v_mfma_f32_16x16x32_bf16 v[40:43], v[120:123], v[100:103], v[40:43]
  v_perm_b32 v124, v69, v65, s69
  v_perm_b32 v125, v77, v73, s69
  v_perm_b32 v126, v85, v81, s69
  v_perm_b32 v127, v93, v89, s69
  s_nop 1
  v_mfma_f32_16x16x32_bf16 v[44:47], v[124:127], v[100:103], v[44:47]
  v_perm_b32 v120, v70, v66, s68
  v_perm_b32 v121, v78, v74, s68
  v_perm_b32 v122, v86, v82, s68
  v_perm_b32 v123, v94, v90, s68
  s_nop 1
  v_mfma_f32_16x16x32_bf16 v[48:51], v[120:123], v[100:103], v[48:51]
  v_perm_b32 v124, v70, v66, s69
  v_perm_b32 v125, v78, v74, s69
  v_perm_b32 v126, v86, v82, s69
  v_perm_b32 v127, v94, v90, s69
  s_nop 1
  v_mfma_f32_16x16x32_bf16 v[52:55], v[124:127], v[100:103], v[52:55]
  v_perm_b32 v120, v71, v67, s68
  v_perm_b32 v121, v79, v75, s68
  v_perm_b32 v122, v87, v83, s68
  v_perm_b32 v123, v95, v91, s68
  s_nop 1
  v_mfma_f32_16x16x32_bf16 v[56:59], v[120:123], v[100:103], v[56:59]
  v_perm_b32 v124, v71, v67, s69
  v_perm_b32 v125, v79, v75, s69
  v_perm_b32 v126, v87, v83, s69
  v_perm_b32 v127, v95, v91, s69
  s_nop 1
  v_mfma_f32_16x16x32_bf16 v[60:63], v[124:127], v[100:103], v[60:63]
L_27:
  s_mov_b32 exec_lo, 0x00ff00ff
  s_mov_b32 exec_hi, 0xff00ff00
  ds_write_b128 v14, v[32:35] offset:12288
  ds_write_b128 v14, v[36:39] offset:12304
  ds_write_b128 v14, v[40:43] offset:12320
  ds_write_b128 v14, v[44:47] offset:12336
  ds_write_b128 v14, v[48:51] offset:12352
  ds_write_b128 v14, v[52:55] offset:12368
  ds_write_b128 v14, v[56:59] offset:12384
  ds_write_b128 v14, v[60:63] offset:12400
  s_mov_b64 exec, -1
L_role_26:
  v_add_f32_dpp v148, v149, v148 quad_perm:[2,3,0,1] row_mask:0xf bank_mask:0xf
  v_add_f32_dpp v150, v151, v150 quad_perm:[2,3,0,1] row_mask:0xf bank_mask:0xf
  v_add_f32_dpp v152, v153, v152 quad_perm:[2,3,0,1] row_mask:0xf bank_mask:0xf
  v_add_f32_dpp v154, v155, v154 quad_perm:[2,3,0,1] row_mask:0xf bank_mask:0xf
  v_max3_f32 v11, v148, v150, v11
  v_max3_f32 v11, v152, v154, v11
  s_waitcnt vmcnt(3)
  buffer_load_dwordx4 v[212:215], v1, s[36:39], s65 offen offset:128 nt
  v_mfma_f32_16x16x32_bf16 v[156:159], v[192:195], v[16:19], 0
  v_mfma_f32_16x16x32_bf16 v[156:159], v[196:199], v[20:23], v[156:159]
  s_waitcnt vmcnt(3)
  buffer_load_dwordx4 v[216:219], v1, s[36:39], s65 offen offset:2048 nt
  s_cmp_lg_u32 s78, 2
  s_cbranch_scc1 L_role_28
  s_waitcnt lgkmcnt(0)
  s_barrier
  ds_read_b32 v32, v13 offset:12288
  ds_read_b32 v33, v13 offset:14592
  ds_read_b32 v34, v13 offset:16896
  ds_read_b32 v35, v13 offset:19200
  ds_read_b32 v36, v13 offset:21504
  ds_read_b32 v37, v13 offset:23808
  ds_read_b32 v38, v13 offset:26112
  ds_read_b32 v39, v13 offset:28416
  ds_read_b32 v40, v13 offset:30720
  ds_read_b32 v41, v13 offset:33024
  ds_read_b32 v42, v13 offset:35328
  ds_read_b32 v43, v13 offset:37632
  ds_read_b32 v44, v13 offset:39936
  ds_read_b32 v45, v13 offset:42240
  ds_read_b32 v46, v13 offset:44544
  ds_read_b32 v47, v13 offset:46848
  s_waitcnt lgkmcnt(0)
  v_pk_add_f32 v[32:33], v[32:33], v[40:41]
  v_pk_add_f32 v[34:35], v[34:35], v[42:43]
  v_pk_add_f32 v[36:37], v[36:37], v[44:45]
  v_pk_add_f32 v[38:39], v[38:39], v[46:47]
  v_pk_add_f32 v[32:33], v[32:33], v[36:37]
  v_pk_add_f32 v[34:35], v[34:35], v[38:39]
  v_pk_add_f32 v[32:33], v[32:33], v[34:35]
  v_add_f32 v32, v32, v33
  v_lshlrev_b32 v6, 16, v10
  v_add_f32 v32, v32, v6
  v_mul_f32 v6, v32, v32
  v_mov_b32 v7, 0xc0135761
  v_fmac_f32 v7, 0xbdd2d3e8, v6
  v_mul_f32 v7, v7, v32
  v_exp_f32 v7, v7
  s_nop 0
  v_add_f32 v7, 1.0, v7
  v_rcp_f32 v7, v7
  s_nop 0
  v_mul_f32 v32, v32, v7
  v_cvt_pk_bf16_f32 v32, v32, v32
  v_perm_b32 v32, v32, v12, s68
  s_mul_i32 s70, s3, 18432
  s_lshl_b32 s71, s76, 8
  s_add_u32 s70, s70, s71
  s_add_u32 s70, s70, 1048576
  v_lshlrev_b32 v5, 2, v0
  buffer_store_dword v32, v5, s[44:47], s70 offen
  s_cmp_lg_u32 s7, 0
  s_cbranch_scc1 L_pub_29
  s_xor_b32 s70, s70, 2097152
  buffer_store_dword v32, v5, s[44:47], s70 offen sc1
L_pub_29:
L_role_28:
  s_nop 3
  v_add_f32_dpp v156, v157, v156 quad_perm:[2,3,0,1] row_mask:0xf bank_mask:0xf
  v_add_f32_dpp v158, v159, v158 quad_perm:[2,3,0,1] row_mask:0xf bank_mask:0xf
  v_max3_f32 v11, v156, v158, v11
  s_waitcnt vmcnt(3)
  buffer_load_dwordx4 v[220:223], v1, s[36:39], s65 offen offset:2176 nt
  v_mfma_f32_16x16x32_bf16 v[160:163], v[200:203], v[16:19], 0
  v_mfma_f32_16x16x32_bf16 v[160:163], v[204:207], v[20:23], v[160:163]
  s_waitcnt vmcnt(3)
  buffer_load_dwordx4 v[224:227], v1, s[36:39], s66 offen offset:0 nt
  s_nop 5
  v_add_f32_dpp v160, v161, v160 quad_perm:[2,3,0,1] row_mask:0xf bank_mask:0xf
  v_add_f32_dpp v162, v163, v162 quad_perm:[2,3,0,1] row_mask:0xf bank_mask:0xf
  v_max3_f32 v11, v160, v162, v11
  s_waitcnt vmcnt(3)
  buffer_load_dwordx4 v[228:231], v1, s[36:39], s66 offen offset:128 nt
  v_mfma_f32_16x16x32_bf16 v[164:167], v[208:211], v[16:19], 0
  v_mfma_f32_16x16x32_bf16 v[164:167], v[212:215], v[20:23], v[164:167]
  s_waitcnt vmcnt(3)
  buffer_load_dwordx4 v[232:235], v1, s[36:39], s66 offen offset:2048 nt
  s_nop 5
  v_add_f32_dpp v164, v165, v164 quad_perm:[2,3,0,1] row_mask:0xf bank_mask:0xf
  v_add_f32_dpp v166, v167, v166 quad_perm:[2,3,0,1] row_mask:0xf bank_mask:0xf
  v_max3_f32 v11, v164, v166, v11
  s_waitcnt vmcnt(3)
  buffer_load_dwordx4 v[236:239], v1, s[36:39], s66 offen offset:2176 nt
  v_mfma_f32_16x16x32_bf16 v[168:171], v[216:219], v[16:19], 0
  v_mfma_f32_16x16x32_bf16 v[168:171], v[220:223], v[20:23], v[168:171]
  s_waitcnt vmcnt(3)
  buffer_load_dwordx4 v[240:243], v1, s[36:39], s67 offen offset:0 nt
  s_nop 5
  v_add_f32_dpp v168, v169, v168 quad_perm:[2,3,0,1] row_mask:0xf bank_mask:0xf
  v_add_f32_dpp v170, v171, v170 quad_perm:[2,3,0,1] row_mask:0xf bank_mask:0xf
  v_max3_f32 v11, v168, v170, v11
  s_waitcnt vmcnt(3)
  buffer_load_dwordx4 v[244:247], v1, s[36:39], s67 offen offset:128 nt
  v_mfma_f32_16x16x32_bf16 v[172:175], v[224:227], v[16:19], 0
  v_mfma_f32_16x16x32_bf16 v[172:175], v[228:231], v[20:23], v[172:175]
  s_waitcnt vmcnt(3)
  buffer_load_dwordx4 v[248:251], v1, s[36:39], s67 offen offset:2048 nt
  s_nop 5
  v_add_f32_dpp v172, v173, v172 quad_perm:[2,3,0,1] row_mask:0xf bank_mask:0xf
  v_add_f32_dpp v174, v175, v174 quad_perm:[2,3,0,1] row_mask:0xf bank_mask:0xf
  v_max3_f32 v11, v172, v174, v11
  s_waitcnt vmcnt(3)
  buffer_load_dwordx4 v[252:255], v1, s[36:39], s67 offen offset:2176 nt
  v_mfma_f32_16x16x32_bf16 v[176:179], v[232:235], v[16:19], 0
  v_mfma_f32_16x16x32_bf16 v[176:179], v[236:239], v[20:23], v[176:179]
  s_waitcnt vmcnt(3)
  buffer_load_dwordx4 v[32:35], v2, s[40:43], s60 offen offset:0 nt
  s_nop 5
  v_add_f32_dpp v176, v177, v176 quad_perm:[2,3,0,1] row_mask:0xf bank_mask:0xf
  v_add_f32_dpp v178, v179, v178 quad_perm:[2,3,0,1] row_mask:0xf bank_mask:0xf
  v_max3_f32 v11, v176, v178, v11
  s_waitcnt vmcnt(3)
  buffer_load_dwordx4 v[36:39], v2, s[40:43], s60 offen offset:1024 nt
  v_mfma_f32_16x16x32_bf16 v[180:183], v[240:243], v[16:19], 0
  v_mfma_f32_16x16x32_bf16 v[180:183], v[244:247], v[20:23], v[180:183]
  s_waitcnt vmcnt(3)
  buffer_load_dwordx4 v[40:43], v2, s[40:43], s60 offen offset:2048 nt
  s_nop 5
  v_add_f32_dpp v180, v181, v180 quad_perm:[2,3,0,1] row_mask:0xf bank_mask:0xf
  v_add_f32_dpp v182, v183, v182 quad_perm:[2,3,0,1] row_mask:0xf bank_mask:0xf
  v_max3_f32 v11, v180, v182, v11
  s_waitcnt vmcnt(3)
  buffer_load_dwordx4 v[44:47], v2, s[40:43], s60 offen offset:3072 nt
  v_mfma_f32_16x16x32_bf16 v[184:187], v[248:251], v[16:19], 0
  v_mfma_f32_16x16x32_bf16 v[184:187], v[252:255], v[20:23], v[184:187]
  s_waitcnt vmcnt(3)
  buffer_load_dwordx4 v[48:51], v2, s[40:43], s61 offen offset:0 nt
  s_nop 5
  v_add_f32_dpp v184, v185, v184 quad_perm:[2,3,0,1] row_mask:0xf bank_mask:0xf
  v_add_f32_dpp v186, v187, v186 quad_perm:[2,3,0,1] row_mask:0xf bank_mask:0xf
  v_max3_f32 v11, v184, v186, v11
  v_mov_b32 v5, v11
  s_nop 1
  v_permlane16_swap_b32 v11, v5
  v_max_f32 v11, v11, v5
  v_mov_b32 v5, v11
  s_nop 1
  v_permlane32_swap_b32 v11, v5
  v_max_f32 v11, v11, v5
  v_and_b32 v6, 1, v0
  v_lshlrev_b32 v6, 5, v6
  s_lshl_b32 s70, s3, 2
  v_add_u32 v7, s70, v6
  s_mov_b64 exec, 3
  ds_write_b32 v7, v11 offset:2048
  s_mov_b64 exec, -1
  s_waitcnt vmcnt(3)
  buffer_load_dwordx4 v[52:55], v2, s[40:43], s61 offen offset:1024 nt
  s_waitcnt lgkmcnt(0)
  s_barrier
  ds_read_b128 v[192:195], v6 offset:2048
  ds_read_b128 v[196:199], v6 offset:2064
  v_mov_b32 v208, 0x3f803f80
  v_mov_b32 v209, 0x3f803f80
  v_mov_b32 v210, 0x3f803f80
  v_mov_b32 v211, 0x3f803f80
  s_mov_b32 s100, 0x3e0293ee
  s_waitcnt lgkmcnt(0)
  v_max3_f32 v11, v192, v193, v194
  v_max3_f32 v11, v195, v196, v11
  v_max3_f32 v11, v197, v198, v11
  v_max_f32 v11, v199, v11
  v_mul_f32 v11, s100, v11
  s_waitcnt vmcnt(3)
  buffer_load_dwordx4 v[56:59], v2, s[40:43], s61 offen offset:2048 nt
  s_cmp_lg_u32 s78, 1
  s_cbranch_scc1 L_role_30
  v_mul_u32_u24 v1, 18432, v4
  v_lshl_add_u32 v1, v3, 2, v1
  s_lshl_b32 s71, s3, 8
  s_add_u32 s71, s71, 1048576
  s_mul_i32 s70, s77, 2304
  s_add_u32 s10, s70, s71
  v_mov_b32 v216, v12
  v_mov_b32 v217, v12
  v_mov_b32 v218, v12
  v_mov_b32 v219, v12
  v_mov_b32 v220, v12
  v_mov_b32 v221, v12
  v_mov_b32 v222, v12
  v_mov_b32 v223, v12
  buffer_load_dwordx4 v[16:19], v1, s[44:47], s10 offen sc1
  buffer_load_dwordx4 v[20:23], v1, s[44:47], s10 offen offset:16 sc1
  s_cmp_lg_u32 s3, 7
  s_cbranch_scc1 L_31
  buffer_load_dwordx4 v[216:219], v1, s[44:47], s10 offen offset:256 sc1
  buffer_load_dwordx4 v[220:223], v1, s[44:47], s10 offen offset:272 sc1
L_31:
L_role_30:
  v_fma_f32 v24, v24, s100, -v11
  v_fma_f32 v26, v26, s100, -v11
  v_exp_f32 v24, v24
  v_exp_f32 v26, v26
  v_fma_f32 v128, v128, s100, -v11
  v_fma_f32 v130, v130, s100, -v11
  v_exp_f32 v128, v128
  v_exp_f32 v130, v130
  v_fma_f32 v132, v132, s100, -v11
  v_fma_f32 v134, v134, s100, -v11
  v_exp_f32 v132, v132
  v_exp_f32 v134, v134
  v_fma_f32 v136, v136, s100, -v11
  v_fma_f32 v138, v138, s100, -v11
  v_exp_f32 v136, v136
  v_exp_f32 v138, v138
  v_cvt_pk_bf16_f32 v192, v24, v26
  v_cvt_pk_bf16_f32 v193, v128, v130
  v_cvt_pk_bf16_f32 v194, v132, v134
  v_cvt_pk_bf16_f32 v195, v136, v138
  v_fma_f32 v140, v140, s100, -v11
  v_fma_f32 v142, v142, s100, -v11
  v_exp_f32 v140, v140
  v_exp_f32 v142, v142
  v_fma_f32 v144, v144, s100, -v11
  v_fma_f32 v146, v146, s100, -v11
  v_exp_f32 v144, v144
  v_exp_f32 v146, v146
  v_fma_f32 v148, v148, s100, -v11
  v_fma_f32 v150, v150, s100, -v11
  v_exp_f32 v148, v148
  v_exp_f32 v150, v150
  v_fma_f32 v152, v152, s100, -v11
  v_fma_f32 v154, v154, s100, -v11
  v_exp_f32 v152, v152
  v_exp_f32 v154, v154
  v_cvt_pk_bf16_f32 v196, v140, v142
  v_cvt_pk_bf16_f32 v197, v144, v146
  v_cvt_pk_bf16_f32 v198, v148, v150
  v_cvt_pk_bf16_f32 v199, v152, v154
  s_waitcnt vmcnt(3)
  buffer_load_dwordx4 v[60:63], v2, s[40:43], s61 offen offset:3072 nt
  v_fma_f32 v156, v156, s100, -v11
  v_fma_f32 v158, v158, s100, -v11
  v_exp_f32 v156, v156
  v_exp_f32 v158, v158
  v_fma_f32 v160, v160, s100, -v11
  v_fma_f32 v162, v162, s100, -v11
  v_exp_f32 v160, v160
  v_exp_f32 v162, v162
  v_fma_f32 v164, v164, s100, -v11
  v_fma_f32 v166, v166, s100, -v11
  v_exp_f32 v164, v164
  v_exp_f32 v166, v166
  v_fma_f32 v168, v168, s100, -v11
  v_fma_f32 v170, v170, s100, -v11
  v_exp_f32 v168, v168
  v_exp_f32 v170, v170
  v_cvt_pk_bf16_f32 v200, v156, v158
  v_cvt_pk_bf16_f32 v201, v160, v162
  v_cvt_pk_bf16_f32 v202, v164, v166
  v_cvt_pk_bf16_f32 v203, v168, v170
  v_fma_f32 v172, v172, s100, -v11
  v_fma_f32 v174, v174, s100, -v11
  v_exp_f32 v172, v172
  v_exp_f32 v174, v174
  v_fma_f32 v176, v176, s100, -v11
  v_fma_f32 v178, v178, s100, -v11
  v_exp_f32 v176, v176
  v_exp_f32 v178, v178
  v_fma_f32 v180, v180, s100, -v11
  v_fma_f32 v182, v182, s100, -v11
  v_exp_f32 v180, v180
  v_exp_f32 v182, v182
  v_fma_f32 v184, v184, s100, -v11
  v_fma_f32 v186, v186, s100, -v11
  v_exp_f32 v184, v184
  v_exp_f32 v186, v186
  v_cvt_pk_bf16_f32 v204, v172, v174
  v_cvt_pk_bf16_f32 v205, v176, v178
  v_cvt_pk_bf16_f32 v206, v180, v182
  v_cvt_pk_bf16_f32 v207, v184, v186
  v_mfma_f32_16x16x32_bf16 v[212:215], v[192:195], v[208:211], 0
  v_mfma_f32_16x16x32_bf16 v[212:215], v[196:199], v[208:211], v[212:215]
  v_mfma_f32_16x16x32_bf16 v[212:215], v[200:203], v[208:211], v[212:215]
  v_mfma_f32_16x16x32_bf16 v[212:215], v[204:207], v[208:211], v[212:215]
  s_waitcnt vmcnt(3)
  buffer_load_dwordx4 v[64:67], v2, s[40:43], s62 offen offset:0 nt
  s_lshl_b32 s70, s3, 2
  v_mov_b32 v7, s70
  s_mov_b64 exec, 1
  s_nop 2
  ds_write_b32 v7, v212 offset:2112
  ds_write_b32 v7, v213 offset:2144
  s_mov_b64 exec, -1
  s_cmp_lg_u32 s78, 0
  s_cbranch_scc1 L_role_32
  v_and_b32 v5, 15, v0
  v_lshlrev_b32 v5, 3, v5
  v_lshrrev_b32 v6, 4, v0
  v_lshl_add_u32 v5, v6, 8, v5
  s_lshl_b32 s70, s3, 13
  s_add_u32 s70, s70, 73728
  v_add_u32 v5, s70, v5
  ds_read_b64 v[224:225], v5 offset:0
  ds_read_b64 v[226:227], v5 offset:128
  ds_read_b64 v[228:229], v5 offset:1024
  ds_read_b64 v[230:231], v5 offset:1152
  ds_read_b64 v[232:233], v5 offset:2048
  ds_read_b64 v[234:235], v5 offset:2176
  ds_read_b64 v[236:237], v5 offset:3072
  ds_read_b64 v[238:239], v5 offset:3200
  ds_read_b64 v[240:241], v5 offset:4096
  ds_read_b64 v[242:243], v5 offset:4224
  ds_read_b64 v[244:245], v5 offset:5120
  ds_read_b64 v[246:247], v5 offset:5248
  ds_read_b64 v[248:249], v5 offset:6144
  ds_read_b64 v[250:251], v5 offset:6272
  ds_read_b64 v[252:253], v5 offset:7168
  ds_read_b64 v[254:255], v5 offset:7296
  v_bfe_u32 v7, v0, 3, 1
  v_mul_u32_u24 v7, 2304, v7
  v_mul_u32_u24 v8, 272, v4
  v_lshl_add_u32 v7, v6, 6, v7
  s_mul_i32 s70, s3, 4608
  v_add3_u32 v14, v7, v8, s70
  v_and_b32 v7, 3, v0
  v_lshlrev_b32 v7, 4, v7
  v_lshl_add_u32 v7, v6, 6, v7
  v_bfe_u32 v8, v0, 2, 2
  v_lshl_add_u32 v7, v8, 2, v7
  s_mul_i32 s70, s3, 272
  v_add_u32 v13, s70, v7
  s_waitcnt lgkmcnt(0)
  v_perm_b32 v160, v228, v224, s68
  v_perm_b32 v161, v236, v232, s68
  v_perm_b32 v162, v244, v240, s68
  v_perm_b32 v163, v252, v248, s68
  v_perm_b32 v164, v228, v224, s69
  v_perm_b32 v165, v236, v232, s69
  v_perm_b32 v166, v244, v240, s69
  v_perm_b32 v167, v252, v248, s69
  v_perm_b32 v168, v229, v225, s68
  v_perm_b32 v169, v237, v233, s68
  v_perm_b32 v170, v245, v241, s68
  v_perm_b32 v171, v253, v249, s68
  v_perm_b32 v172, v229, v225, s69
  v_perm_b32 v173, v237, v233, s69
  v_perm_b32 v174, v245, v241, s69
  v_perm_b32 v175, v253, v249, s69
  v_perm_b32 v176, v230, v226, s68
  v_perm_b32 v177, v238, v234, s68
  v_perm_b32 v178, v246, v242, s68
  v_perm_b32 v179, v254, v250, s68
  v_perm_b32 v180, v230, v226, s69
  v_perm_b32 v181, v238, v234, s69
  v_perm_b32 v182, v246, v242, s69
  v_perm_b32 v183, v254, v250, s69
  v_perm_b32 v184, v231, v227, s68
  v_perm_b32 v185, v239, v235, s68
  v_perm_b32 v186, v247, v243, s68
  v_perm_b32 v187, v255, v251, s68
  v_perm_b32 v188, v231, v227, s69
  v_perm_b32 v189, v239, v235, s69
  v_perm_b32 v190, v247, v243, s69
  v_perm_b32 v191, v255, v251, s69
L_role_32:
  s_cmp_lg_u32 s78, 0
  s_cbranch_scc1 L_role_33
  s_mul_i32 s71, s3, 1152
  s_add_u32 s48, s8, s71
  s_addc_u32 s49, s9, 0
  s_mov_b32 s50, 1152
  s_mov_b32 s51, 0x20000
  s_mov_b32 s56, s28
  s_mov_b32 s57, s29
  s_mov_b32 s58, 1152
  s_mov_b32 s59, 0x20000
  v_lshlrev_b32 v5, 5, v0
  buffer_load_dwordx4 v[224:227], v5, s[48:51], 0 offen offset:0
  buffer_load_dwordx4 v[232:235], v5, s[56:59], 0 offen offset:0
  buffer_load_dwordx4 v[228:231], v5, s[48:51], 0 offen offset:16
  buffer_load_dwordx4 v[236:239], v5, s[56:59], 0 offen offset:16
  s_cmp_eq_u32 s77, 0
  s_cselect_b32 s70, 1152, 0
  s_mov_b32 s52, s26
  s_mov_b32 s53, s27
  s_mov_b32 s54, s70
  s_mov_b32 s55, 0x20000
  v_lshlrev_b32 v5, 1, v0
  s_lshl_b32 s70, s76, 7
  buffer_load_ushort v9, v5, s[52:55], s70 offen
L_role_33:
  s_waitcnt vmcnt(3)
  buffer_load_dwordx4 v[68:71], v2, s[40:43], s62 offen offset:1024 nt
  s_waitcnt vmcnt(3)
  buffer_load_dwordx4 v[72:75], v2, s[40:43], s62 offen offset:2048 nt
  s_cmp_lg_u32 s78, 1
  s_cbranch_scc1 L_role_34
  s_mov_b32 s79, 400000
L_poll_35:
  v_bitop3_b32 v160, v16, v17, v12 bitop3:0x7e
  v_bitop3_b32 v161, v18, v19, v12 bitop3:0x7e
  v_bitop3_b32 v162, v20, v21, v12 bitop3:0x7e
  v_bitop3_b32 v163, v22, v23, v12 bitop3:0x7e
  v_bitop3_b32 v164, v216, v217, v12 bitop3:0x7e
  v_bitop3_b32 v165, v218, v219, v12 bitop3:0x7e
  v_bitop3_b32 v166, v220, v221, v12 bitop3:0x7e
  v_bitop3_b32 v167, v222, v223, v12 bitop3:0x7e
  v_or3_b32 v160, v160, v161, v162
  v_or3_b32 v163, v163, v164, v165
  v_or3_b32 v160, v160, v166, v167
  v_or_b32 v160, v160, v163
  v_and_b32 v160, 0xffff, v160
  v_cmp_ne_u32 vcc, 0, v160
  s_nop 0
  s_cbranch_vccz L_ok_36
  s_sub_u32 s79, s79, 1
  s_cbranch_scc1 L_ok_36
  s_sleep 4
  s_xor_b32 s10, s10, 2097152
  buffer_load_dwordx4 v[16:19], v1, s[44:47], s10 offen sc1
  buffer_load_dwordx4 v[20:23], v1, s[44:47], s10 offen offset:16 sc1
  s_cmp_lg_u32 s3, 7
  s_cbranch_scc1 L_37
  buffer_load_dwordx4 v[216:219], v1, s[44:47], s10 offen offset:256 sc1
  buffer_load_dwordx4 v[220:223], v1, s[44:47], s10 offen offset:272 sc1
L_37:
  s_waitcnt vmcnt(0)
  s_branch L_poll_35
L_ok_36:
  v_perm_b32 v16, v17, v16, s69
  v_perm_b32 v17, v19, v18, s69
  v_perm_b32 v18, v21, v20, s69
  v_perm_b32 v19, v23, v22, s69
  v_perm_b32 v20, v217, v216, s69
  v_perm_b32 v21, v219, v218, s69
  v_perm_b32 v22, v221, v220, s69
  v_perm_b32 v23, v223, v222, s69
  v_add_u32 v5, 73728, v15
  ds_read_b128 v[224:227], v5 offset:0
  ds_read_b128 v[228:231], v5 offset:1024
  ds_read_b128 v[232:235], v5 offset:2048
  ds_read_b128 v[236:239], v5 offset:3072
  ds_read_b128 v[240:243], v5 offset:4096
  ds_read_b128 v[244:247], v5 offset:5120
  ds_read_b128 v[248:251], v5 offset:6144
  ds_read_b128 v[252:255], v5 offset:7168
  s_waitcnt lgkmcnt(0)
  v_perm_b32 v24, v228, v224, s68
  v_perm_b32 v25, v236, v232, s68
  v_perm_b32 v26, v244, v240, s68
  v_perm_b32 v27, v252, v248, s68
  s_nop 1
  v_mfma_f32_16x16x32_bf16 v[160:163], v[24:27], v[16:19], 0
  v_perm_b32 v28, v228, v224, s69
  v_perm_b32 v29, v236, v232, s69
  v_perm_b32 v30, v244, v240, s69
  v_perm_b32 v31, v252, v248, s69
  s_nop 1
  v_mfma_f32_16x16x32_bf16 v[164:167], v[28:31], v[16:19], 0
  v_perm_b32 v24, v229, v225, s68
  v_perm_b32 v25, v237, v233, s68
  v_perm_b32 v26, v245, v241, s68
  v_perm_b32 v27, v253, v249, s68
  s_nop 1
  v_mfma_f32_16x16x32_bf16 v[168:171], v[24:27], v[16:19], 0
  v_perm_b32 v28, v229, v225, s69
  v_perm_b32 v29, v237, v233, s69
  v_perm_b32 v30, v245, v241, s69
  v_perm_b32 v31, v253, v249, s69
  s_nop 1
  v_mfma_f32_16x16x32_bf16 v[172:175], v[28:31], v[16:19], 0
  v_perm_b32 v24, v230, v226, s68
  v_perm_b32 v25, v238, v234, s68
  v_perm_b32 v26, v246, v242, s68
  v_perm_b32 v27, v254, v250, s68
  s_nop 1
  v_mfma_f32_16x16x32_bf16 v[176:179], v[24:27], v[16:19], 0
  v_perm_b32 v28, v230, v226, s69
  v_perm_b32 v29, v238, v234, s69
  v_perm_b32 v30, v246, v242, s69
  v_perm_b32 v31, v254, v250, s69
  s_nop 1
  v_mfma_f32_16x16x32_bf16 v[180:183], v[28:31], v[16:19], 0
  v_perm_b32 v24, v231, v227, s68
  v_perm_b32 v25, v239, v235, s68
  v_perm_b32 v26, v247, v243, s68
  v_perm_b32 v27, v255, v251, s68
  s_nop 1
  v_mfma_f32_16x16x32_bf16 v[184:187], v[24:27], v[16:19], 0
  v_perm_b32 v28, v231, v227, s69
  v_perm_b32 v29, v239, v235, s69
  v_perm_b32 v30, v247, v243, s69
  v_perm_b32 v31, v255, v251, s69
  s_nop 1
  v_mfma_f32_16x16x32_bf16 v[188:191], v[28:31], v[16:19], 0
L_role_34:
  s_waitcnt vmcnt(3)
  buffer_load_dwordx4 v[76:79], v2, s[40:43], s62 offen offset:3072 nt
  v_perm_b32 v24, v36, v32, s68
  v_perm_b32 v25, v44, v40, s68
  v_perm_b32 v26, v52, v48, s68
  v_perm_b32 v27, v60, v56, s68
  s_nop 1
  v_mfma_f32_16x16x32_bf16 v[128:131], v[192:195], v[24:27], 0
  v_perm_b32 v28, v36, v32, s69
  v_perm_b32 v29, v44, v40, s69
  v_perm_b32 v30, v52, v48, s69
  v_perm_b32 v31, v60, v56, s69
  s_nop 1
  v_mfma_f32_16x16x32_bf16 v[132:135], v[192:195], v[28:31], 0
  v_perm_b32 v24, v37, v33, s68
  v_perm_b32 v25, v45, v41, s68
  v_perm_b32 v26, v53, v49, s68
  v_perm_b32 v27, v61, v57, s68
  s_nop 1
  v_mfma_f32_16x16x32_bf16 v[136:139], v[192:195], v[24:27], 0
  v_perm_b32 v28, v37, v33, s69
  v_perm_b32 v29, v45, v41, s69
  v_perm_b32 v30, v53, v49, s69
  v_perm_b32 v31, v61, v57, s69
  s_nop 1
  v_mfma_f32_16x16x32_bf16 v[140:143], v[192:195], v[28:31], 0
  v_perm_b32 v24, v38, v34, s68
  v_perm_b32 v25, v46, v42, s68
  v_perm_b32 v26, v54, v50, s68
  v_perm_b32 v27, v62, v58, s68
  s_nop 1
  v_mfma_f32_16x16x32_bf16 v[144:147], v[192:195], v[24:27], 0
  v_perm_b32 v28, v38, v34, s69
  v_perm_b32 v29, v46, v42, s69
  v_perm_b32 v30, v54, v50, s69
  v_perm_b32 v31, v62, v58, s69
  s_nop 1
  v_mfma_f32_16x16x32_bf16 v[148:151], v[192:195], v[28:31], 0
  v_perm_b32 v24, v39, v35, s68
  v_perm_b32 v25, v47, v43, s68
  v_perm_b32 v26, v55, v51, s68
  v_perm_b32 v27, v63, v59, s68
  s_nop 1
  v_mfma_f32_16x16x32_bf16 v[152:155], v[192:195], v[24:27], 0
  v_perm_b32 v28, v39, v35, s69
  v_perm_b32 v29, v47, v43, s69
  v_perm_b32 v30, v55, v51, s69
  v_perm_b32 v31, v63, v59, s69
  s_nop 1
  v_mfma_f32_16x16x32_bf16 v[156:159], v[192:195], v[28:31], 0
  s_waitcnt vmcnt(3)
  buffer_load_dwordx4 v[80:83], v2, s[40:43], s63 offen offset:0 nt
  s_cmp_lg_u32 s78, 1
  s_cbranch_scc1 L_role_38
  s_cmp_lg_u32 s3, 7
  s_cbranch_scc1 L_39
  v_add_u32 v5, 81920, v15
  ds_read_b128 v[224:227], v5 offset:0
  ds_read_b128 v[228:231], v5 offset:1024
  ds_read_b128 v[232:235], v5 offset:2048
  ds_read_b128 v[236:239], v5 offset:3072
  ds_read_b128 v[240:243], v5 offset:4096
  ds_read_b128 v[244:247], v5 offset:5120
  ds_read_b128 v[248:251], v5 offset:6144
  ds_read_b128 v[252:255], v5 offset:7168
  s_waitcnt lgkmcnt(0)
  v_perm_b32 v24, v228, v224, s68
  v_perm_b32 v25, v236, v232, s68
  v_perm_b32 v26, v244, v240, s68
  v_perm_b32 v27, v252, v248, s68
  s_nop 1
  v_mfma_f32_16x16x32_bf16 v[160:163], v[24:27], v[20:23], v[160:163]
  v_perm_b32 v28, v228, v224, s69
  v_perm_b32 v29, v236, v232, s69
  v_perm_b32 v30, v244, v240, s69
  v_perm_b32 v31, v252, v248, s69
  s_nop 1
  v_mfma_f32_16x16x32_bf16 v[164:167], v[28:31], v[20:23], v[164:167]
  v_perm_b32 v24, v229, v225, s68
  v_perm_b32 v25, v237, v233, s68
  v_perm_b32 v26, v245, v241, s68
  v_perm_b32 v27, v253, v249, s68
  s_nop 1
  v_mfma_f32_16x16x32_bf16 v[168:171], v[24:27], v[20:23], v[168:171]
  v_perm_b32 v28, v229, v225, s69
  v_perm_b32 v29, v237, v233, s69
  v_perm_b32 v30, v245, v241, s69
  v_perm_b32 v31, v253, v249, s69
  s_nop 1
  v_mfma_f32_16x16x32_bf16 v[172:175], v[28:31], v[20:23], v[172:175]
  v_perm_b32 v24, v230, v226, s68
  v_perm_b32 v25, v238, v234, s68
  v_perm_b32 v26, v246, v242, s68
  v_perm_b32 v27, v254, v250, s68
  s_nop 1
  v_mfma_f32_16x16x32_bf16 v[176:179], v[24:27], v[20:23], v[176:179]
  v_perm_b32 v28, v230, v226, s69
  v_perm_b32 v29, v238, v234, s69
  v_perm_b32 v30, v246, v242, s69
  v_perm_b32 v31, v254, v250, s69
  s_nop 1
  v_mfma_f32_16x16x32_bf16 v[180:183], v[28:31], v[20:23], v[180:183]
  v_perm_b32 v24, v231, v227, s68
  v_perm_b32 v25, v239, v235, s68
  v_perm_b32 v26, v247, v243, s68
  v_perm_b32 v27, v255, v251, s68
  s_nop 1
  v_mfma_f32_16x16x32_bf16 v[184:187], v[24:27], v[20:23], v[184:187]
  v_perm_b32 v28, v231, v227, s69
  v_perm_b32 v29, v239, v235, s69
  v_perm_b32 v30, v247, v243, s69
  v_perm_b32 v31, v255, v251, s69
  s_nop 1
  v_mfma_f32_16x16x32_bf16 v[188:191], v[28:31], v[20:23], v[188:191]
L_39:
  s_mov_b32 exec_lo, 0x00ff00ff
  s_mov_b32 exec_hi, 0xff00ff00
  ds_write_b128 v14, v[160:163] offset:12288
  ds_write_b128 v14, v[164:167] offset:12304
  ds_write_b128 v14, v[168:171] offset:12320
  ds_write_b128 v14, v[172:175] offset:12336
  ds_write_b128 v14, v[176:179] offset:12352
  ds_write_b128 v14, v[180:183] offset:12368
  ds_write_b128 v14, v[184:187] offset:12384
  ds_write_b128 v14, v[188:191] offset:12400
  s_mov_b64 exec, -1
L_role_38:
  s_cmp_lg_u32 s78, 0
  s_cbranch_scc1 L_role_40
  v_dot2_f32_bf16 v11, v224, v232, 0
  v_dot2_f32_bf16 v11, v225, v233, v11
  v_dot2_f32_bf16 v11, v226, v234, v11
  v_dot2_f32_bf16 v11, v227, v235, v11
  v_dot2_f32_bf16 v11, v228, v236, v11
  v_dot2_f32_bf16 v11, v229, v237, v11
  v_dot2_f32_bf16 v11, v230, v238, v11
  v_dot2_f32_bf16 v11, v231, v239, v11
  s_nop 2
  v_add_f32_dpp v11, v11, v11 row_ror:8 row_mask:0xf bank_mask:0xf
  s_nop 1
  v_add_f32_dpp v11, v11, v11 row_ror:4 row_mask:0xf bank_mask:0xf
  s_nop 1
  v_add_f32_dpp v11, v11, v11 row_ror:2 row_mask:0xf bank_mask:0xf
  s_nop 1
  v_add_f32_dpp v11, v11, v11 row_ror:1 row_mask:0xf bank_mask:0xf
  v_mov_b32 v6, v11
  s_nop 1
  v_permlane16_swap_b32 v11, v6
  v_add_f32 v11, v11, v6
  v_mov_b32 v6, v11
  s_nop 1
  v_permlane32_swap_b32 v11, v6
  v_add_f32 v11, v11, v6
  v_mul_f32 v11, 0xbfb8aa3b, v11
  v_exp_f32 v11, v11
  s_nop 0
  v_add_f32 v11, 1.0, v11
  v_rcp_f32 v11, v11
  v_lshlrev_b32 v9, 16, v9
L_role_40:
  s_waitcnt vmcnt(3)
  buffer_load_dwordx4 v[84:87], v2, s[40:43], s63 offen offset:1024 nt
  s_waitcnt vmcnt(3)
  buffer_load_dwordx4 v[88:91], v2, s[40:43], s63 offen offset:2048 nt
  s_waitcnt lgkmcnt(0)
  s_barrier
  s_cmp_lg_u32 s3, 7
  s_cbranch_scc1 L_41
  v_lshrrev_b32 v5, 5, v0
  v_lshlrev_b32 v6, 5, v5
  ds_read_b128 v[32:35], v6 offset:2048
  ds_read_b128 v[36:39], v6 offset:2064
  ds_read_b128 v[40:43], v6 offset:2112
  ds_read_b128 v[44:47], v6 offset:2128
  v_lshlrev_b32 v15, 4, v5
  s_lshl_b32 s70, s19, 6
  s_add_u32 s70, s70, 16384
  v_mov_b32 v217, v12
  v_mov_b32 v219, v12
  s_waitcnt lgkmcnt(0)
  v_max3_f32 v216, v32, v33, v34
  v_max3_f32 v216, v35, v36, v216
  v_max3_f32 v216, v37, v38, v216
  v_max_f32 v216, v39, v216
  v_mul_f32 v216, s100, v216
  v_pk_add_f32 v[40:41], v[40:41], v[44:45]
  v_pk_add_f32 v[42:43], v[42:43], v[46:47]
  v_pk_add_f32 v[40:41], v[40:41], v[42:43]
  v_add_f32 v218, v40, v41
  s_mov_b32 exec_lo, 1
  s_mov_b32 exec_hi, 1
  buffer_store_dwordx4 v[216:219], v15, s[44:47], s70 offen
  s_cmp_lg_u32 s7, 0
  s_cbranch_scc1 L_pub_42
  s_xor_b32 s70, s70, 2097152
  buffer_store_dwordx4 v[216:219], v15, s[44:47], s70 offen sc1
L_pub_42:
  s_mov_b64 exec, -1
L_41:
  s_cmp_lg_u32 s78, 1
  s_cbranch_scc1 L_43
  s_mul_i32 s70, s77, 9
  s_add_u32 s70, s70, s76
  s_lshl_b32 s70, s70, 3
  s_add_u32 s70, s70, s3
  s_lshl_b32 s70, s70, 8
  s_add_u32 s71, s70, 65536
  ds_read_b32 v32, v13 offset:12288
  ds_read_b32 v33, v13 offset:14592
  ds_read_b32 v34, v13 offset:16896
  ds_read_b32 v35, v13 offset:19200
  ds_read_b32 v36, v13 offset:21504
  ds_read_b32 v37, v13 offset:23808
  ds_read_b32 v38, v13 offset:26112
  ds_read_b32 v39, v13 offset:28416
  ds_read_b32 v40, v13 offset:30720
  ds_read_b32 v41, v13 offset:33024
  ds_read_b32 v42, v13 offset:35328
  ds_read_b32 v43, v13 offset:37632
  ds_read_b32 v44, v13 offset:39936
  ds_read_b32 v45, v13 offset:42240
  ds_read_b32 v46, v13 offset:44544
  ds_read_b32 v47, v13 offset:46848
  s_waitcnt lgkmcnt(0)
  v_pk_add_f32 v[32:33], v[32:33], v[40:41]
  v_pk_add_f32 v[34:35], v[34:35], v[42:43]
  v_pk_add_f32 v[36:37], v[36:37], v[44:45]
  v_pk_add_f32 v[38:39], v[38:39], v[46:47]
  v_pk_add_f32 v[32:33], v[32:33], v[36:37]
  v_pk_add_f32 v[34:35], v[34:35], v[38:39]
  v_pk_add_f32 v[32:33], v[32:33], v[34:35]
  v_add_f32 v32, v32, v33
  v_add_u32 v32, 2048, v32
  v_bfi_b32 v32, s6, v12, v32
  v_lshlrev_b32 v6, 2, v0
  buffer_store_dword v32, v6, s[44:47], s71 offen
  s_cmp_lg_u32 s7, 0
  s_cbranch_scc1 L_pub_44
  s_xor_b32 s71, s71, 2097152
  buffer_store_dword v32, v6, s[44:47], s71 offen sc1
L_pub_44:
L_43:
  s_waitcnt vmcnt(3)
  buffer_load_dwordx4 v[92:95], v2, s[40:43], s63 offen offset:3072 nt
  s_waitcnt vmcnt(3)
  buffer_load_dwordx4 v[96:99], v2, s[40:43], s64 offen offset:0 nt
  s_waitcnt vmcnt(3)
  buffer_load_dwordx4 v[100:103], v2, s[40:43], s64 offen offset:1024 nt
  s_waitcnt vmcnt(3)
  buffer_load_dwordx4 v[104:107], v2, s[40:43], s64 offen offset:2048 nt
  s_waitcnt vmcnt(3)
  buffer_load_dwordx4 v[108:111], v2, s[40:43], s64 offen offset:3072 nt
  v_perm_b32 v24, v68, v64, s68
  v_perm_b32 v25, v76, v72, s68
  v_perm_b32 v26, v84, v80, s68
  v_perm_b32 v27, v92, v88, s68
  s_nop 1
  v_mfma_f32_16x16x32_bf16 v[128:131], v[196:199], v[24:27], v[128:131]
  v_perm_b32 v28, v68, v64, s69
  v_perm_b32 v29, v76, v72, s69
  v_perm_b32 v30, v84, v80, s69
  v_perm_b32 v31, v92, v88, s69
  s_nop 1
  v_mfma_f32_16x16x32_bf16 v[132:135], v[196:199], v[28:31], v[132:135]
  v_perm_b32 v24, v69, v65, s68
  v_perm_b32 v25, v77, v73, s68
  v_perm_b32 v26, v85, v81, s68
  v_perm_b32 v27, v93, v89, s68
  s_nop 1
  v_mfma_f32_16x16x32_bf16 v[136:139], v[196:199], v[24:27], v[136:139]
  v_perm_b32 v28, v69, v65, s69
  v_perm_b32 v29, v77, v73, s69
  v_perm_b32 v30, v85, v81, s69
  v_perm_b32 v31, v93, v89, s69
  s_nop 1
  v_mfma_f32_16x16x32_bf16 v[140:143], v[196:199], v[28:31], v[140:143]
  v_perm_b32 v24, v70, v66, s68
  v_perm_b32 v25, v78, v74, s68
  v_perm_b32 v26, v86, v82, s68
  v_perm_b32 v27, v94, v90, s68
  s_nop 1
  v_mfma_f32_16x16x32_bf16 v[144:147], v[196:199], v[24:27], v[144:147]
  v_perm_b32 v28, v70, v66, s69
  v_perm_b32 v29, v78, v74, s69
  v_perm_b32 v30, v86, v82, s69
  v_perm_b32 v31, v94, v90, s69
  s_nop 1
  v_mfma_f32_16x16x32_bf16 v[148:151], v[196:199], v[28:31], v[148:151]
  v_perm_b32 v24, v71, v67, s68
  v_perm_b32 v25, v79, v75, s68
  v_perm_b32 v26, v87, v83, s68
  v_perm_b32 v27, v95, v91, s68
  s_nop 1
  v_mfma_f32_16x16x32_bf16 v[152:155], v[196:199], v[24:27], v[152:155]
  v_perm_b32 v28, v71, v67, s69
  v_perm_b32 v29, v79, v75, s69
  v_perm_b32 v30, v87, v83, s69
  v_perm_b32 v31, v95, v91, s69
  s_nop 1
  v_mfma_f32_16x16x32_bf16 v[156:159], v[196:199], v[28:31], v[156:159]
  s_waitcnt vmcnt(3)
  buffer_load_dwordx4 v[112:115], v2, s[40:43], s65 offen offset:0 nt
  s_waitcnt vmcnt(3)
  buffer_load_dwordx4 v[116:119], v2, s[40:43], s65 offen offset:1024 nt
  s_waitcnt vmcnt(3)
  buffer_load_dwordx4 v[120:123], v2, s[40:43], s65 offen offset:2048 nt
  s_waitcnt vmcnt(3)
  s_cmp_lg_u32 s78, 0
  s_cbranch_scc1 L_role_45
  s_mul_i32 s70, s77, 9
  s_add_u32 s70, s70, s76
  s_lshl_b32 s70, s70, 3
  s_add_u32 s70, s70, s3
  s_lshl_b32 s70, s70, 8
  s_add_u32 s10, s70, 65536
  v_lshlrev_b32 v1, 2, v0
  buffer_load_dword v16, v1, s[44:47], s10 offen sc1
L_role_45:
  buffer_load_dwordx4 v[124:127], v2, s[40:43], s65 offen offset:3072 nt
  s_waitcnt vmcnt(3)
  buffer_load_dwordx4 v[224:227], v2, s[40:43], s66 offen offset:0 nt
  s_waitcnt vmcnt(3)
  buffer_load_dwordx4 v[228:231], v2, s[40:43], s66 offen offset:1024 nt
  s_waitcnt vmcnt(3)
  s_cmp_lg_u32 s3, 7
  s_cbranch_scc1 L_wave_46
  s_xor_b32 s74, s19, 1
  s_lshl_b32 s74, s74, 6
  s_add_u32 s74, s74, 16384
  buffer_load_dwordx4 v[220:223], v15, s[44:47], s74 offen sc1
L_wave_46:
  buffer_load_dwordx4 v[232:235], v2, s[40:43], s66 offen offset:2048 nt
  s_waitcnt vmcnt(3)
  buffer_load_dwordx4 v[236:239], v2, s[40:43], s66 offen offset:3072 nt
  v_perm_b32 v24, v100, v96, s68
  v_perm_b32 v25, v108, v104, s68
  v_perm_b32 v26, v116, v112, s68
  v_perm_b32 v27, v124, v120, s68
  s_nop 1
  v_mfma_f32_16x16x32_bf16 v[128:131], v[200:203], v[24:27], v[128:131]
  v_perm_b32 v28, v100, v96, s69
  v_perm_b32 v29, v108, v104, s69
  v_perm_b32 v30, v116, v112, s69
  v_perm_b32 v31, v124, v120, s69
  s_nop 1
  v_mfma_f32_16x16x32_bf16 v[132:135], v[200:203], v[28:31], v[132:135]
  v_perm_b32 v24, v101, v97, s68
  v_perm_b32 v25, v109, v105, s68
  v_perm_b32 v26, v117, v113, s68
  v_perm_b32 v27, v125, v121, s68
  s_nop 1
  v_mfma_f32_16x16x32_bf16 v[136:139], v[200:203], v[24:27], v[136:139]
  v_perm_b32 v28, v101, v97, s69
  v_perm_b32 v29, v109, v105, s69
  v_perm_b32 v30, v117, v113, s69
  v_perm_b32 v31, v125, v121, s69
  s_nop 1
  v_mfma_f32_16x16x32_bf16 v[140:143], v[200:203], v[28:31], v[140:143]
  v_perm_b32 v24, v102, v98, s68
  v_perm_b32 v25, v110, v106, s68
  v_perm_b32 v26, v118, v114, s68
  v_perm_b32 v27, v126, v122, s68
  s_nop 1
  v_mfma_f32_16x16x32_bf16 v[144:147], v[200:203], v[24:27], v[144:147]
  v_perm_b32 v28, v102, v98, s69
  v_perm_b32 v29, v110, v106, s69
  v_perm_b32 v30, v118, v114, s69
  v_perm_b32 v31, v126, v122, s69
  s_nop 1
  v_mfma_f32_16x16x32_bf16 v[148:151], v[200:203], v[28:31], v[148:151]
  v_perm_b32 v24, v103, v99, s68
  v_perm_b32 v25, v111, v107, s68
  v_perm_b32 v26, v119, v115, s68
  v_perm_b32 v27, v127, v123, s68
  s_nop 1
  v_mfma_f32_16x16x32_bf16 v[152:155], v[200:203], v[24:27], v[152:155]
  v_perm_b32 v28, v103, v99, s69
  v_perm_b32 v29, v111, v107, s69
  v_perm_b32 v30, v119, v115, s69
  v_perm_b32 v31, v127, v123, s69
  s_nop 1
  v_mfma_f32_16x16x32_bf16 v[156:159], v[200:203], v[28:31], v[156:159]
  s_waitcnt vmcnt(3)
  buffer_load_dwordx4 v[240:243], v2, s[40:43], s67 offen offset:0 nt
  s_waitcnt vmcnt(3)
  buffer_load_dwordx4 v[244:247], v2, s[40:43], s67 offen offset:1024 nt
  s_waitcnt vmcnt(3)
  buffer_load_dwordx4 v[248:251], v2, s[40:43], s67 offen offset:2048 nt
  s_cmp_lg_u32 s78, 0
  s_cbranch_scc1 L_role_47
  s_mov_b32 s79, 400000
L_poll_48:
  v_xor_b32 v16, s5, v16
  v_and_b32 v5, s6, v16
  v_cmp_ne_u32 vcc, 0, v5
  s_nop 0
  s_cbranch_vccz L_ok_49
  s_sub_u32 s79, s79, 1
  s_cbranch_scc1 L_ok_49
  s_sleep 4
  s_xor_b32 s10, s10, 2097152
  buffer_load_dword v16, v1, s[44:47], s10 offen sc1
  s_waitcnt vmcnt(0)
  s_branch L_poll_48
L_ok_49:
  v_add_f32 v9, v9, v16
  v_sub_f32 v5, 1.0, v11
  v_mul_f32 v9, v9, v5
  s_lshl_b32 s11, s77, 3
  s_add_u32 s11, s11, s3
  s_lshl_b32 s11, s11, 12
  s_add_u32 s11, s11, 262144
  s_lshl_b32 s73, s76, 3
  s_add_u32 s73, s73, s3
  s_lshl_b32 s73, s73, 3
  s_add_u32 s73, s73, s77
  s_lshl_b32 s73, s73, 8
  s_add_u32 s73, s73, 1310720
L_role_47:
  s_waitcnt vmcnt(3)
  buffer_load_dwordx4 v[252:255], v2, s[40:43], s67 offen offset:3072 nt
  s_cmp_lg_u32 s3, 7
  s_cbranch_scc1 L_wave_50
  s_mov_b32 s79, 400000
L_poll_51:
  v_bitop3_b32 v5, v221, v223, v12 bitop3:0x7e
  v_cmp_ne_u32 vcc, 0, v5
  s_nop 0
  s_cbranch_vccz L_ok_52
  s_sub_u32 s79, s79, 1
  s_cbranch_scc1 L_ok_52
  s_sleep 4
  s_xor_b32 s74, s74, 2097152
  buffer_load_dwordx4 v[220:223], v15, s[44:47], s74 offen sc1
  s_waitcnt vmcnt(0)
  s_branch L_poll_51
L_ok_52:
  v_sub_f32 v6, v220, v216
  v_max_f32 v5, 0, v6
  v_sub_f32 v7, v6, v5
  v_sub_f32 v6, 0, v5
  v_exp_f32 v6, v6
  v_exp_f32 v7, v7
  v_mul_f32 v5, v6, v218
  v_fmac_f32 v5, v7, v222
  v_rcp_f32 v5, v5
  s_nop 0
  v_mul_f32 v10, v5, v6
  v_lshrrev_b32 v5, 3, v0
  v_lshlrev_b32 v15, 11, v5
  v_bfe_u32 v5, v0, 1, 2
  v_lshl_or_b32 v15, v5, 8, v15
  v_and_b32 v5, 1, v0
  v_lshl_or_b32 v15, v5, 10, v15
  s_bfe_u32 s74, s19, 0x40001
  s_lshl_b32 s74, s74, 14
  s_and_b32 s71, s19, 1
  s_lshl_b32 s71, s71, 7
  s_add_u32 s74, s74, s71
  s_lshr_b32 s70, s19, 5
  s_lshl_b32 s70, s70, 4
  s_add_u32 s74, s74, s70
  s_add_u32 s74, s74, 262144
L_wave_50:
  v_and_b32 v5, 15, v0
  v_lshlrev_b32 v5, 5, v5
  s_lshl_b32 s70, s3, 10
  s_add_u32 s70, s70, 4096
  v_add_u32 v5, s70, v5
  s_waitcnt vmcnt(6)
  v_perm_b32 v96, v228, v224, s68
  v_perm_b32 v100, v228, v224, s69
  v_perm_b32 v104, v229, v225, s68
  v_perm_b32 v108, v229, v225, s69
  v_perm_b32 v112, v230, v226, s68
  v_perm_b32 v116, v230, v226, s69
  v_perm_b32 v120, v231, v227, s68
  v_perm_b32 v124, v231, v227, s69
  s_waitcnt vmcnt(4)
  v_perm_b32 v97, v236, v232, s68
  v_perm_b32 v101, v236, v232, s69
  v_perm_b32 v105, v237, v233, s68
  v_perm_b32 v109, v237, v233, s69
  v_perm_b32 v113, v238, v234, s68
  v_perm_b32 v117, v238, v234, s69
  v_perm_b32 v121, v239, v235, s68
  v_perm_b32 v125, v239, v235, s69
  s_waitcnt vmcnt(2)
  v_perm_b32 v98, v244, v240, s68
  v_perm_b32 v102, v244, v240, s69
  v_perm_b32 v106, v245, v241, s68
  v_perm_b32 v110, v245, v241, s69
  v_perm_b32 v114, v246, v242, s68
  v_perm_b32 v118, v246, v242, s69
  v_perm_b32 v122, v247, v243, s68
  v_perm_b32 v126, v247, v243, s69
  s_waitcnt vmcnt(0)
  v_perm_b32 v99, v252, v248, s68
  v_perm_b32 v103, v252, v248, s69
  v_perm_b32 v107, v253, v249, s68
  v_mfma_f32_16x16x32_bf16 v[128:131], v[204:207], v[96:99], v[128:131]
  v_perm_b32 v111, v253, v249, s69
  v_mfma_f32_16x16x32_bf16 v[132:135], v[204:207], v[100:103], v[132:135]
  v_perm_b32 v115, v254, v250, s68
  v_mfma_f32_16x16x32_bf16 v[136:139], v[204:207], v[104:107], v[136:139]
  v_perm_b32 v119, v254, v250, s69
  v_mfma_f32_16x16x32_bf16 v[140:143], v[204:207], v[108:111], v[140:143]
  v_perm_b32 v123, v255, v251, s68
  v_mfma_f32_16x16x32_bf16 v[144:147], v[204:207], v[112:115], v[144:147]
  v_perm_b32 v127, v255, v251, s69
  v_mfma_f32_16x16x32_bf16 v[148:151], v[204:207], v[116:119], v[148:151]
  v_mfma_f32_16x16x32_bf16 v[152:155], v[204:207], v[120:123], v[152:155]
  v_mfma_f32_16x16x32_bf16 v[156:159], v[204:207], v[124:127], v[156:159]
  s_mov_b64 exec, 0xffff
  ds_write2_b32 v5, v128, v129 offset0:0 offset1:128
  ds_write2_b32 v5, v132, v133 offset0:1 offset1:129
  ds_write2_b32 v5, v136, v137 offset0:2 offset1:130
  ds_write2_b32 v5, v140, v141 offset0:3 offset1:131
  ds_write2_b32 v5, v144, v145 offset0:4 offset1:132
  ds_write2_b32 v5, v148, v149 offset0:5 offset1:133
  ds_write2_b32 v5, v152, v153 offset0:6 offset1:134
  ds_write2_b32 v5, v156, v157 offset0:7 offset1:135
  s_mov_b64 exec, -1
  s_waitcnt lgkmcnt(0)
  s_barrier
  s_cmp_lg_u32 s3, 7
  s_cbranch_scc1 L_tail
  s_setprio 3
  ds_read_b128 v[96:99], v2 offset:4096
  ds_read_b128 v[100:103], v2 offset:5120
  ds_read_b128 v[104:107], v2 offset:6144
  ds_read_b128 v[108:111], v2 offset:7168
  ds_read_b128 v[112:115], v2 offset:8192
  ds_read_b128 v[116:119], v2 offset:9216
  ds_read_b128 v[120:123], v2 offset:10240
  ds_read_b128 v[124:127], v2 offset:11264
  s_waitcnt lgkmcnt(0)
  v_pk_add_f32 v[96:97], v[96:97], v[112:113]
  v_pk_add_f32 v[98:99], v[98:99], v[114:115]
  v_pk_add_f32 v[100:101], v[100:101], v[116:117]
  v_pk_add_f32 v[102:103], v[102:103], v[118:119]
  v_pk_add_f32 v[104:105], v[104:105], v[120:121]
  v_pk_add_f32 v[106:107], v[106:107], v[122:123]
  v_pk_add_f32 v[108:109], v[108:109], v[124:125]
  v_pk_add_f32 v[110:111], v[110:111], v[126:127]
  v_pk_add_f32 v[96:97], v[96:97], v[104:105]
  v_pk_add_f32 v[98:99], v[98:99], v[106:107]
  v_pk_add_f32 v[100:101], v[100:101], v[108:109]
  v_pk_add_f32 v[102:103], v[102:103], v[110:111]
  v_pk_add_f32 v[96:97], v[96:97], v[100:101]
  v_pk_add_f32 v[98:99], v[98:99], v[102:103]
  v_mul_f32 v96, v96, v10
  v_mul_f32 v97, v97, v10
  v_mul_f32 v98, v98, v10
  v_mul_f32 v99, v99, v10
  v_cvt_pk_bf16_f32 v216, v96, v97
  v_cvt_pk_bf16_f32 v218, v98, v99
  buffer_store_dwordx4 v[216:219], v15, s[44:47], s74 offen
  s_cmp_lg_u32 s7, 0
  s_cbranch_scc1 L_pub_53
  s_xor_b32 s74, s74, 2097152
  buffer_store_dwordx4 v[216:219], v15, s[44:47], s74 offen sc1
L_pub_53:
  s_setprio 0
L_tail:
  s_cmp_lg_u32 s78, 0
  s_cbranch_scc1 L_nocons
  s_mov_b32 s79, 400000
L_cl:
  buffer_load_dwordx4 v[48:51], v2, s[44:47], s11 offen offset:0 sc1
  buffer_load_dwordx4 v[52:55], v2, s[44:47], s11 offen offset:1024 sc1
  buffer_load_dwordx4 v[56:59], v2, s[44:47], s11 offen offset:2048 sc1
  buffer_load_dwordx4 v[60:63], v2, s[44:47], s11 offen offset:3072 sc1
  s_mov_b64 exec, -1
  s_andn2_b32 s11, s11, 2097152
  s_waitcnt vmcnt(0)
  v_bitop3_b32 v5, v49, v51, v12 bitop3:0x7e
  v_bitop3_b32 v6, v53, v55, v12 bitop3:0x7e
  v_bitop3_b32 v7, v57, v59, v12 bitop3:0x7e
  v_bitop3_b32 v8, v61, v63, v12 bitop3:0x7e
  v_pk_mov_b32 v[16:17], v[48:49], v[50:51] op_sel:[0,0]
  v_or3_b32 v5, v5, v6, v7
  v_pk_mov_b32 v[18:19], v[52:53], v[54:55] op_sel:[0,0]
  v_or_b32 v5, v5, v8
  v_pk_mov_b32 v[20:21], v[56:57], v[58:59] op_sel:[0,0]
  v_cmp_ne_u32 vcc, 0, v5
  v_pk_mov_b32 v[22:23], v[60:61], v[62:63] op_sel:[0,0]
  s_cbranch_vccz L_cok
  s_sub_u32 s79, s79, 1
  s_cbranch_scc1 L_cok
  s_and_b32 s70, s79, 7
  s_cselect_b32 s70, 0, 2097152
  s_or_b32 s11, s11, s70
  s_mov_b64 exec, vcc
  s_bcnt1_i32_b64 s70, vcc
  s_cmp_le_u32 s70, 16
  s_cbranch_scc1 L_cl
  s_sleep 4
  s_branch L_cl
L_cok:
  v_mfma_f32_16x16x32_bf16 v[64:67], v[160:163], v[16:19], 0
  v_mfma_f32_16x16x32_bf16 v[64:67], v[176:179], v[20:23], v[64:67]
  v_mfma_f32_16x16x32_bf16 v[68:71], v[164:167], v[16:19], 0
  v_mfma_f32_16x16x32_bf16 v[68:71], v[180:183], v[20:23], v[68:71]
  v_mfma_f32_16x16x32_bf16 v[72:75], v[168:171], v[16:19], 0
  v_mfma_f32_16x16x32_bf16 v[72:75], v[184:187], v[20:23], v[72:75]
  v_mfma_f32_16x16x32_bf16 v[76:79], v[172:175], v[16:19], 0
  v_mfma_f32_16x16x32_bf16 v[76:79], v[188:191], v[20:23], v[76:79]
  s_nop 1
  ds_write_b128 v14, v[64:67] offset:12288
  s_nop 0
  ds_write_b128 v14, v[68:71] offset:12304
  s_nop 0
  ds_write_b128 v14, v[72:75] offset:12320
  s_nop 0
  ds_write_b128 v14, v[76:79] offset:12336
  s_waitcnt lgkmcnt(0)
  s_barrier
  ds_read_b32 v32, v13 offset:12288
  ds_read_b32 v33, v13 offset:14592
  ds_read_b32 v34, v13 offset:16896
  ds_read_b32 v35, v13 offset:19200
  ds_read_b32 v36, v13 offset:21504
  ds_read_b32 v37, v13 offset:23808
  ds_read_b32 v38, v13 offset:26112
  ds_read_b32 v39, v13 offset:28416
  ds_read_b32 v40, v13 offset:30720
  ds_read_b32 v41, v13 offset:33024
  ds_read_b32 v42, v13 offset:35328
  ds_read_b32 v43, v13 offset:37632
  ds_read_b32 v44, v13 offset:39936
  ds_read_b32 v45, v13 offset:42240
  ds_read_b32 v46, v13 offset:44544
  ds_read_b32 v47, v13 offset:46848
  s_waitcnt lgkmcnt(0)
  v_pk_add_f32 v[32:33], v[32:33], v[40:41]
  v_pk_add_f32 v[34:35], v[34:35], v[42:43]
  v_pk_add_f32 v[36:37], v[36:37], v[44:45]
  v_pk_add_f32 v[38:39], v[38:39], v[46:47]
  v_pk_add_f32 v[32:33], v[32:33], v[36:37]
  v_pk_add_f32 v[34:35], v[34:35], v[38:39]
  v_pk_add_f32 v[32:33], v[32:33], v[34:35]
  v_add_f32 v32, v32, v33
  v_fmac_f32 v9, v32, v11
  v_add_u32 v9, 2048, v9
  v_bfi_b32 v9, s6, v12, v9
  buffer_store_dword v9, v1, s[44:47], s73 offen sc1
  s_branch L_fin
L_nocons:
  s_cmp_ge_u32 s101, 72
  s_cbranch_scc1 L_fin
  s_lshl_b32 s70, s101, 11
  s_add_u32 s70, s70, 1310720
  buffer_load_dwordx4 v[32:35], v2, s[44:47], s70 offen sc1
  buffer_load_dwordx4 v[36:39], v2, s[44:47], s70 offen offset:1024 sc1
  s_and_b32 s71, s101, 7
  s_mul_i32 s71, s71, 1152
  v_bfe_u32 v5, v0, 4, 1
  v_lshlrev_b32 v5, 1, v5
  v_lshrrev_b32 v6, 5, v0
  v_or_b32 v5, v5, v6
  v_and_b32 v6, 15, v0
  v_lshl_or_b32 v5, v6, 2, v5
  s_lshr_b32 s72, s101, 3
  s_lshl_b32 s72, s72, 6
  v_add_lshl_u32 v15, v5, s72, 1
  s_mov_b32 s52, s30
  s_mov_b32 s53, s31
  s_mov_b32 s54, 9216
  s_mov_b32 s55, 0x20000
  s_mov_b32 s79, 400000
  s_sleep 2
  buffer_load_dwordx4 v[40:43], v2, s[44:47], s70 offen sc1
  buffer_load_dwordx4 v[44:47], v2, s[44:47], s70 offen offset:1024 sc1
  s_sleep 2
  buffer_load_dwordx4 v[48:51], v2, s[44:47], s70 offen sc1
  buffer_load_dwordx4 v[52:55], v2, s[44:47], s70 offen offset:1024 sc1
L_r1:
  s_waitcnt vmcnt(4)
  v_xor_b32 v32, s5, v32
  v_xor_b32 v33, s5, v33
  v_xor_b32 v34, s5, v34
  v_xor_b32 v35, s5, v35
  v_xor_b32 v36, s5, v36
  v_xor_b32 v37, s5, v37
  v_xor_b32 v38, s5, v38
  v_xor_b32 v39, s5, v39
  v_or3_b32 v5, v32, v33, v34
  v_or3_b32 v5, v35, v36, v5
  v_or3_b32 v5, v37, v38, v5
  v_or_b32 v5, v39, v5
  v_and_b32 v5, s6, v5
  v_cmp_ne_u32 vcc, 0, v5
  s_nop 0
  s_cbranch_vccz L_r1ok0
  buffer_load_dwordx4 v[32:35], v2, s[44:47], s70 offen sc1
  buffer_load_dwordx4 v[36:39], v2, s[44:47], s70 offen offset:1024 sc1
  s_waitcnt vmcnt(4)
  v_xor_b32 v40, s5, v40
  v_xor_b32 v41, s5, v41
  v_xor_b32 v42, s5, v42
  v_xor_b32 v43, s5, v43
  v_xor_b32 v44, s5, v44
  v_xor_b32 v45, s5, v45
  v_xor_b32 v46, s5, v46
  v_xor_b32 v47, s5, v47
  v_or3_b32 v5, v40, v41, v42
  v_or3_b32 v5, v43, v44, v5
  v_or3_b32 v5, v45, v46, v5
  v_or_b32 v5, v47, v5
  v_and_b32 v5, s6, v5
  v_cmp_ne_u32 vcc, 0, v5
  s_nop 0
  s_cbranch_vccz L_r1ok1
  buffer_load_dwordx4 v[40:43], v2, s[44:47], s70 offen sc1
  buffer_load_dwordx4 v[44:47], v2, s[44:47], s70 offen offset:1024 sc1
  s_waitcnt vmcnt(4)
  v_xor_b32 v48, s5, v48
  v_xor_b32 v49, s5, v49
  v_xor_b32 v50, s5, v50
  v_xor_b32 v51, s5, v51
  v_xor_b32 v52, s5, v52
  v_xor_b32 v53, s5, v53
  v_xor_b32 v54, s5, v54
  v_xor_b32 v55, s5, v55
  v_or3_b32 v5, v48, v49, v50
  v_or3_b32 v5, v51, v52, v5
  v_or3_b32 v5, v53, v54, v5
  v_or_b32 v5, v55, v5
  v_and_b32 v5, s6, v5
  v_cmp_ne_u32 vcc, 0, v5
  s_nop 0
  s_cbranch_vccz L_r1ok2
  buffer_load_dwordx4 v[48:51], v2, s[44:47], s70 offen sc1
  buffer_load_dwordx4 v[52:55], v2, s[44:47], s70 offen offset:1024 sc1
  s_sub_u32 s79, s79, 1
  s_cbranch_scc0 L_r1
L_r1ok0:
  v_pk_add_f32 v[224:225], v[32:33], v[36:37]
  v_pk_add_f32 v[226:227], v[34:35], v[38:39]
  s_branch L_r1fin
L_r1ok1:
  v_pk_add_f32 v[224:225], v[40:41], v[44:45]
  v_pk_add_f32 v[226:227], v[42:43], v[46:47]
  s_branch L_r1fin
L_r1ok2:
  v_pk_add_f32 v[224:225], v[48:49], v[52:53]
  v_pk_add_f32 v[226:227], v[50:51], v[54:55]
L_r1fin:
  s_nop 0
  v_permlane32_swap_b32 v224, v225
  v_permlane32_swap_b32 v226, v227
  v_add_f32 v224, v224, v225
  v_add_f32 v226, v226, v227
  s_nop 1
  v_permlane16_swap_b32 v224, v226
  v_add_f32 v224, v224, v226
  v_cvt_pk_bf16_f32 v224, v224, v224
  buffer_store_short v224, v15, s[52:55], s71 offen
  s_cmp_lg_u32 s101, 0
  s_cbranch_scc1 L_fin
  s_mov_b64 exec, 1
  buffer_store_dword v12, off, s[44:47], 0 offset:0
L_fin:
L_end:
  s_endpgm
.section .rodata,"a"
.p2align 6
.amdhsa_kernel gated_mix__sliding_block_cached__mixer_channel_mlp__decode_kernel
  .amdhsa_next_free_vgpr 256
  .amdhsa_next_free_sgpr 102
  .amdhsa_accum_offset 256
  .amdhsa_group_segment_fixed_size 0
  .amdhsa_kernarg_size 112
  .amdhsa_user_sgpr_count 2
  .amdhsa_user_sgpr_kernarg_segment_ptr 1
  .amdhsa_system_sgpr_workgroup_id_x 1
  .amdhsa_float_denorm_mode_32 3
.end_amdhsa_kernel
```
